```python
import torch

def _softmax(x, axis=-1):
    return torch.softmax(x, dim=axis)
def _gelu(x):
    return torch.nn.functional.gelu(x, approximate="tanh")
def _silu(x):
    return torch.nn.functional.silu(x)
def _sigmoid(x):
    return torch.sigmoid(x)
def _layernorm(x, axis=-1, eps=1e-5):
    m = x.mean(dim=axis, keepdim=True)
    v = x.var(dim=axis, keepdim=True, unbiased=False)
    return (x - m) / torch.sqrt(v + eps)
def _scatter_add(tgt, idx, src, axis=0):
    return tgt.clone().index_add_(axis, idx, src)
def _segment_sum(src, seg, n):
    out = torch.zeros((n,) + src.shape[1:], dtype=src.dtype)
    return out.index_add_(0, seg, src)
def _pad(x, pw):
    flat = tuple(v for pair in reversed(pw) for v in pair)
    return torch.nn.functional.pad(x, flat)

kernel_name = 'gated_mix__linear_kernel_hedgehog__mixer_s_mlp__prompt'

def setup_inputs():

    _w = (lambda a: (lambda t: t.to(torch.bfloat16) if t.is_floating_point() else t)(torch.as_tensor(a)))
    def _A_setup():
        B, S, D, H = 1, 2048, 1024, 32
        Dh = D // H
        return {
            "x": _w((lambda *s: torch.randn(*s, dtype=torch.bfloat16) * 0.05)(B, S, D)),
            "wqkv": _w((lambda *s: torch.randn(*s, dtype=torch.bfloat16) * 1.6)(D, 3 * D)),
            "w_phi": _w((lambda *s: torch.randn(*s, dtype=torch.bfloat16) * 1.6)(H, Dh, Dh) * (Dh ** -0.5)),
            "wo": _w((lambda *s: torch.randn(*s, dtype=torch.bfloat16) * 0.8)(D, D)),
        }
    _A_in = _A_setup()

    def _B_setup():
        B, S, D, F = 1, 2048, 1024, 3584
        return {
            "x":  _w((lambda *s: torch.randn(*s, dtype=torch.bfloat16) * 0.05)(B, S, D)),
            "w1": _w((lambda *s: torch.randn(*s, dtype=torch.bfloat16) * 3.2)(D, D) * (D ** -0.5)),
            "w2": _w((lambda *s: torch.randn(*s, dtype=torch.bfloat16) * 3.2)(D, D) * (D ** -0.5)),
            "w3": _w((lambda *s: torch.randn(*s, dtype=torch.bfloat16) * 3.2)(D, F) * (D ** -0.5)),
            "w4": _w((lambda *s: torch.randn(*s, dtype=torch.bfloat16) * 1.6)(F, D) * (F ** -0.5)),
        }
    _B_in = _B_setup()

    return {
        "A_x": _A_in["x"],
        "A_wqkv": _A_in["wqkv"],
        "A_w_phi": _A_in["w_phi"],
        "A_wo": _A_in["wo"],
        "B_x": _B_in["x"],
        "B_w1": _B_in["w1"],
        "B_w2": _B_in["w2"],
        "B_w3": _B_in["w3"],
        "B_w4": _B_in["w4"],
        "gate_w": _w((lambda *s: torch.randn(*s, dtype=torch.bfloat16) * 0.05)(1024) * 16.0),
    }

def reference(A_x, A_wqkv, A_w_phi, A_wo, B_x, B_w1, B_w2, B_w3, B_w4, gate_w):
    def _A_ref(x, wqkv, w_phi, wo):
        B, S, D = x.shape
        H = 32; Dh = D // H
        qkv = (lambda x, *d: x.permute(*d))((x @ wqkv).reshape(B, S, 3, H, Dh), 2, 0, 3, 1, 4)
        q, k, v = qkv[0], qkv[1], qkv[2]
        pq = torch.einsum("bhsd,hdf->bhsf", q, w_phi)
        pk = torch.einsum("bhsd,hdf->bhsf", k, w_phi)
        phi_q = torch.concatenate([_softmax(pq, axis=-1), _softmax(-pq, axis=-1)], axis=-1)
        phi_k = torch.concatenate([_softmax(pk, axis=-1), _softmax(-pk, axis=-1)], axis=-1)
        kv = torch.einsum("bhsf,bhsd->bhfd", phi_k, v)
        z  = torch.einsum("bhsf->bhf", phi_k)
        num = torch.einsum("bhqf,bhfd->bhqd", phi_q, kv)
        den = torch.einsum("bhqf,bhf->bhq", phi_q, z)[..., None] + 1e-6
        o = num / den
        return (lambda x, *d: x.permute(*d))(o, 0, 2, 1, 3).reshape(B, S, D) @ wo

    def _B_ref(x, w1, w2, w3, w4):
        B, S, D = x.shape
        h = _gelu(_layernorm(x, axis=-1) @ w1)
        c = D // 4
        g0 = _pad(h[:, :, 0*c:1*c], ((0, 0), (1, 0), (0, 0)))[:, :S, :]
        g1 = _pad(h[:, :, 1*c:2*c], ((0, 0), (0, 1), (0, 0)))[:, 1:, :]
        g2 = _pad(h[:, :, 2*c:3*c], ((0, 0), (2, 0), (0, 0)))[:, :S, :]
        g3 = _pad(h[:, :, 3*c:   ], ((0, 0), (0, 2), (0, 0)))[:, 2:, :]
        hs = torch.concatenate([g0, g1, g2, g3], axis=-1) @ w2
        x1 = x + hs
        h2 = _gelu(_layernorm(x1, axis=-1) @ w3) @ w4
        return x1 + h2

    x = A_x
    g = _sigmoid((x * gate_w).sum(-1, keepdims=True))
    a = _A_ref(x, A_wqkv, A_w_phi, A_wo)
    b = _B_ref(x, B_w1, B_w2, B_w3, B_w4)
    return g * a + (1 - g) * b
```

```asm
; @launch kernel=prep_kernel grid=(1024,1,1) block=(256,1,1) lds=0
; @launch kernel=gemm1_kernel grid=(256,1,1) block=(512,1,1) lds=147456
; @launch kernel=g2kv_kernel grid=(512,1,1) block=(256,1,1) lds=73728
; @launch kernel=ln1_kernel grid=(512,1,1) block=(256,1,1) lds=0
; @launch kernel=g4at_kernel grid=(256,1,1) block=(512,1,1) lds=147456
; @launch kernel=gemm5_kernel grid=(256,1,1) block=(512,1,1) lds=131072
.amdgcn_target "amdgcn-amd-amdhsa--gfx950"
.text
.globl prep_kernel
.p2align 8
.type prep_kernel,@function
prep_kernel:
    s_cmp_ge_u32 s2, 1024
    s_cbranch_scc1 END_prep_kernel_1
    s_load_dwordx2 s[4:5], s[0:1], 0
    s_load_dwordx2 s[6:7], s[0:1], 96
    s_load_dwordx2 s[8:9], s[0:1], 0
    s_load_dwordx2 s[10:11], s[0:1], 72
    v_lshrrev_b32 v1, 6, v0
    s_nop 0
    v_readfirstlane_b32 s12, v1
    s_load_dwordx2 s[44:45], s[0:1], 8
    s_load_dwordx2 s[46:47], s[0:1], 40
    s_waitcnt lgkmcnt(0)
    s_cmp_eq_u32 s12, s12
    s_cbranch_scc1 NOPF_prep_kernel_2
    s_add_u32 s32, s44, 0x0
    s_addc_u32 s33, s45, 0
    s_mov_b32 s34, 0x600000
    s_mov_b32 s35, 0x00020000
    s_add_u32 s36, s46, 0x0
    s_addc_u32 s37, s47, 0
    s_mov_b32 s38, 0x200000
    s_mov_b32 s39, 0x00020000
    v_lshlrev_b32 v2, 7, v0
    v_mov_b32 v3, 0x7ffffff0
    v_cmp_gt_u32 vcc, 48, v0
    v_cndmask_b32 v2, v3, v2, vcc
    s_mul_i32 s40, s2, 6144
    buffer_load_dword v47, v2, s[32:35], s40 offen
    v_lshlrev_b32 v2, 7, v0
    v_cmp_gt_u32 vcc, 16, v0
    v_cndmask_b32 v2, v3, v2, vcc
    s_lshl_b32 s40, s2, 11
    buffer_load_dword v47, v2, s[36:39], s40 offen
NOPF_prep_kernel_2:
    s_cmp_lg_u32 s2, 0
    s_cbranch_scc1 NOZERO_prep_kernel_3
    s_add_u32 s28, s6, 0x3500000
    s_addc_u32 s29, s7, 0
    s_mov_b32 s30, 0x400
    s_mov_b32 s31, 0x00020000
    v_lshlrev_b32 v1, 2, v0
    v_mov_b32 v2, 0
    buffer_store_dword v2, v1, s[28:31], 0 offen
NOZERO_prep_kernel_3:
    s_cmp_ge_u32 s2, 512
    s_cbranch_scc1 GATE_prep_kernel_4
    s_lshl_b32 s13, s2, 2
    s_add_u32 s13, s13, s12
    s_add_u32 s16, s4, 0x0
    s_addc_u32 s17, s5, 0
    s_mov_b32 s18, 0x400000
    s_mov_b32 s19, 0x00020000
    s_add_u32 s20, s6, 0x0
    s_addc_u32 s21, s7, 0
    s_mov_b32 s22, 0x400000
    s_mov_b32 s23, 0x00020000
    v_and_b32 v1, 63, v0
    v_lshlrev_b32 v2, 4, v1
    s_lshl_b32 s40, s13, 11
    v_add_u32 v2, s40, v2
    buffer_load_dwordx4 v[8:11], v2, s[16:19], 0 offen
    buffer_load_dwordx4 v[12:15], v2, s[16:19], 0 offen offset:1024
    v_lshlrev_b32 v3, 2, v1
    s_waitcnt vmcnt(0)
    v_lshlrev_b32 v16, 16, v8
    v_and_b32 v17, 0xffff0000, v8
    v_lshlrev_b32 v18, 16, v9
    v_and_b32 v19, 0xffff0000, v9
    v_lshlrev_b32 v20, 16, v10
    v_and_b32 v21, 0xffff0000, v10
    v_lshlrev_b32 v22, 16, v11
    v_and_b32 v23, 0xffff0000, v11
    v_lshlrev_b32 v24, 16, v12
    v_and_b32 v25, 0xffff0000, v12
    v_lshlrev_b32 v26, 16, v13
    v_and_b32 v27, 0xffff0000, v13
    v_lshlrev_b32 v28, 16, v14
    v_and_b32 v29, 0xffff0000, v14
    v_lshlrev_b32 v30, 16, v15
    v_and_b32 v31, 0xffff0000, v15
    v_add_f32 v4, v16, v17
    v_add_f32 v4, v4, v18
    v_add_f32 v4, v4, v19
    v_add_f32 v4, v4, v20
    v_add_f32 v4, v4, v21
    v_add_f32 v4, v4, v22
    v_add_f32 v4, v4, v23
    v_add_f32 v4, v4, v24
    v_add_f32 v4, v4, v25
    v_add_f32 v4, v4, v26
    v_add_f32 v4, v4, v27
    v_add_f32 v4, v4, v28
    v_add_f32 v4, v4, v29
    v_add_f32 v4, v4, v30
    v_add_f32 v4, v4, v31
    v_xor_b32 v5, 4, v3
    ds_bpermute_b32 v5, v5, v4
    s_waitcnt lgkmcnt(0)
    v_add_f32 v4, v4, v5
    v_xor_b32 v5, 8, v3
    ds_bpermute_b32 v5, v5, v4
    s_waitcnt lgkmcnt(0)
    v_add_f32 v4, v4, v5
    v_xor_b32 v5, 16, v3
    ds_bpermute_b32 v5, v5, v4
    s_waitcnt lgkmcnt(0)
    v_add_f32 v4, v4, v5
    v_xor_b32 v5, 32, v3
    ds_bpermute_b32 v5, v5, v4
    s_waitcnt lgkmcnt(0)
    v_add_f32 v4, v4, v5
    v_xor_b32 v5, 64, v3
    ds_bpermute_b32 v5, v5, v4
    s_waitcnt lgkmcnt(0)
    v_add_f32 v4, v4, v5
    v_xor_b32 v5, 128, v3
    ds_bpermute_b32 v5, v5, v4
    s_waitcnt lgkmcnt(0)
    v_add_f32 v4, v4, v5
    v_mul_f32 v4, 0x3a800000, v4
    v_sub_f32 v5, v16, v4
    v_mul_f32 v6, v5, v5
    v_sub_f32 v5, v17, v4
    v_fmac_f32 v6, v5, v5
    v_sub_f32 v5, v18, v4
    v_fmac_f32 v6, v5, v5
    v_sub_f32 v5, v19, v4
    v_fmac_f32 v6, v5, v5
    v_sub_f32 v5, v20, v4
    v_fmac_f32 v6, v5, v5
    v_sub_f32 v5, v21, v4
    v_fmac_f32 v6, v5, v5
    v_sub_f32 v5, v22, v4
    v_fmac_f32 v6, v5, v5
    v_sub_f32 v5, v23, v4
    v_fmac_f32 v6, v5, v5
    v_sub_f32 v5, v24, v4
    v_fmac_f32 v6, v5, v5
    v_sub_f32 v5, v25, v4
    v_fmac_f32 v6, v5, v5
    v_sub_f32 v5, v26, v4
    v_fmac_f32 v6, v5, v5
    v_sub_f32 v5, v27, v4
    v_fmac_f32 v6, v5, v5
    v_sub_f32 v5, v28, v4
    v_fmac_f32 v6, v5, v5
    v_sub_f32 v5, v29, v4
    v_fmac_f32 v6, v5, v5
    v_sub_f32 v5, v30, v4
    v_fmac_f32 v6, v5, v5
    v_sub_f32 v5, v31, v4
    v_fmac_f32 v6, v5, v5
    v_xor_b32 v5, 4, v3
    ds_bpermute_b32 v5, v5, v6
    s_waitcnt lgkmcnt(0)
    v_add_f32 v6, v6, v5
    v_xor_b32 v5, 8, v3
    ds_bpermute_b32 v5, v5, v6
    s_waitcnt lgkmcnt(0)
    v_add_f32 v6, v6, v5
    v_xor_b32 v5, 16, v3
    ds_bpermute_b32 v5, v5, v6
    s_waitcnt lgkmcnt(0)
    v_add_f32 v6, v6, v5
    v_xor_b32 v5, 32, v3
    ds_bpermute_b32 v5, v5, v6
    s_waitcnt lgkmcnt(0)
    v_add_f32 v6, v6, v5
    v_xor_b32 v5, 64, v3
    ds_bpermute_b32 v5, v5, v6
    s_waitcnt lgkmcnt(0)
    v_add_f32 v6, v6, v5
    v_xor_b32 v5, 128, v3
    ds_bpermute_b32 v5, v5, v6
    s_waitcnt lgkmcnt(0)
    v_add_f32 v6, v6, v5
    v_mul_f32 v6, 0x3a800000, v6
    v_cvt_pk_bf16_f32 v4, v4, v4
    v_lshlrev_b32 v4, 16, v4
    v_cvt_pk_bf16_f32 v6, v6, v6
    v_lshlrev_b32 v6, 16, v6
    v_add_f32 v6, 0x3727c5ac, v6
    v_cvt_pk_bf16_f32 v6, v6, v6
    v_lshlrev_b32 v6, 16, v6
    v_sqrt_f32 v6, v6
    s_nop 0
    v_cvt_pk_bf16_f32 v6, v6, v6
    v_lshlrev_b32 v6, 16, v6
    v_rcp_f32 v7, v6
    s_nop 0
    v_sub_f32 v16, v16, v4
    v_cvt_pk_bf16_f32 v16, v16, v16
    v_lshlrev_b32 v16, 16, v16
    v_mul_f32 v5, v16, v7
    v_fma_f32 v32, -v5, v6, v16
    v_fma_f32 v16, v32, v7, v5
    v_sub_f32 v17, v17, v4
    v_cvt_pk_bf16_f32 v17, v17, v17
    v_lshlrev_b32 v17, 16, v17
    v_mul_f32 v5, v17, v7
    v_fma_f32 v32, -v5, v6, v17
    v_fma_f32 v17, v32, v7, v5
    v_sub_f32 v18, v18, v4
    v_cvt_pk_bf16_f32 v18, v18, v18
    v_lshlrev_b32 v18, 16, v18
    v_mul_f32 v5, v18, v7
    v_fma_f32 v32, -v5, v6, v18
    v_fma_f32 v18, v32, v7, v5
    v_sub_f32 v19, v19, v4
    v_cvt_pk_bf16_f32 v19, v19, v19
    v_lshlrev_b32 v19, 16, v19
    v_mul_f32 v5, v19, v7
    v_fma_f32 v32, -v5, v6, v19
    v_fma_f32 v19, v32, v7, v5
    v_sub_f32 v20, v20, v4
    v_cvt_pk_bf16_f32 v20, v20, v20
    v_lshlrev_b32 v20, 16, v20
    v_mul_f32 v5, v20, v7
    v_fma_f32 v32, -v5, v6, v20
    v_fma_f32 v20, v32, v7, v5
    v_sub_f32 v21, v21, v4
    v_cvt_pk_bf16_f32 v21, v21, v21
    v_lshlrev_b32 v21, 16, v21
    v_mul_f32 v5, v21, v7
    v_fma_f32 v32, -v5, v6, v21
    v_fma_f32 v21, v32, v7, v5
    v_sub_f32 v22, v22, v4
    v_cvt_pk_bf16_f32 v22, v22, v22
    v_lshlrev_b32 v22, 16, v22
    v_mul_f32 v5, v22, v7
    v_fma_f32 v32, -v5, v6, v22
    v_fma_f32 v22, v32, v7, v5
    v_sub_f32 v23, v23, v4
    v_cvt_pk_bf16_f32 v23, v23, v23
    v_lshlrev_b32 v23, 16, v23
    v_mul_f32 v5, v23, v7
    v_fma_f32 v32, -v5, v6, v23
    v_fma_f32 v23, v32, v7, v5
    v_sub_f32 v24, v24, v4
    v_cvt_pk_bf16_f32 v24, v24, v24
    v_lshlrev_b32 v24, 16, v24
    v_mul_f32 v5, v24, v7
    v_fma_f32 v32, -v5, v6, v24
    v_fma_f32 v24, v32, v7, v5
    v_sub_f32 v25, v25, v4
    v_cvt_pk_bf16_f32 v25, v25, v25
    v_lshlrev_b32 v25, 16, v25
    v_mul_f32 v5, v25, v7
    v_fma_f32 v32, -v5, v6, v25
    v_fma_f32 v25, v32, v7, v5
    v_sub_f32 v26, v26, v4
    v_cvt_pk_bf16_f32 v26, v26, v26
    v_lshlrev_b32 v26, 16, v26
    v_mul_f32 v5, v26, v7
    v_fma_f32 v32, -v5, v6, v26
    v_fma_f32 v26, v32, v7, v5
    v_sub_f32 v27, v27, v4
    v_cvt_pk_bf16_f32 v27, v27, v27
    v_lshlrev_b32 v27, 16, v27
    v_mul_f32 v5, v27, v7
    v_fma_f32 v32, -v5, v6, v27
    v_fma_f32 v27, v32, v7, v5
    v_sub_f32 v28, v28, v4
    v_cvt_pk_bf16_f32 v28, v28, v28
    v_lshlrev_b32 v28, 16, v28
    v_mul_f32 v5, v28, v7
    v_fma_f32 v32, -v5, v6, v28
    v_fma_f32 v28, v32, v7, v5
    v_sub_f32 v29, v29, v4
    v_cvt_pk_bf16_f32 v29, v29, v29
    v_lshlrev_b32 v29, 16, v29
    v_mul_f32 v5, v29, v7
    v_fma_f32 v32, -v5, v6, v29
    v_fma_f32 v29, v32, v7, v5
    v_sub_f32 v30, v30, v4
    v_cvt_pk_bf16_f32 v30, v30, v30
    v_lshlrev_b32 v30, 16, v30
    v_mul_f32 v5, v30, v7
    v_fma_f32 v32, -v5, v6, v30
    v_fma_f32 v30, v32, v7, v5
    v_sub_f32 v31, v31, v4
    v_cvt_pk_bf16_f32 v31, v31, v31
    v_lshlrev_b32 v31, 16, v31
    v_mul_f32 v5, v31, v7
    v_fma_f32 v32, -v5, v6, v31
    v_fma_f32 v31, v32, v7, v5
    v_cvt_pk_bf16_f32 v8, v16, v17
    v_cvt_pk_bf16_f32 v9, v18, v19
    v_cvt_pk_bf16_f32 v10, v20, v21
    v_cvt_pk_bf16_f32 v11, v22, v23
    v_cvt_pk_bf16_f32 v12, v24, v25
    v_cvt_pk_bf16_f32 v13, v26, v27
    v_cvt_pk_bf16_f32 v14, v28, v29
    v_cvt_pk_bf16_f32 v15, v30, v31
    buffer_store_dwordx4 v[8:11], v2, s[20:23], 0 offen
    buffer_store_dwordx4 v[12:15], v2, s[20:23], 0 offen offset:1024
    s_endpgm
GATE_prep_kernel_4:
    s_sub_u32 s13, s2, 512
    s_lshl_b32 s13, s13, 2
    s_add_u32 s13, s13, s12
    s_add_u32 s16, s8, 0x0
    s_addc_u32 s17, s9, 0
    s_mov_b32 s18, 0x400000
    s_mov_b32 s19, 0x00020000
    s_add_u32 s20, s10, 0x0
    s_addc_u32 s21, s11, 0
    s_mov_b32 s22, 0x800
    s_mov_b32 s23, 0x00020000
    s_add_u32 s24, s6, 0x3400000
    s_addc_u32 s25, s7, 0
    s_mov_b32 s26, 0x2000
    s_mov_b32 s27, 0x00020000
    v_and_b32 v1, 63, v0
    v_lshlrev_b32 v2, 4, v1
    s_lshl_b32 s40, s13, 11
    v_add_u32 v3, s40, v2
    buffer_load_dwordx4 v[8:11], v3, s[16:19], 0 offen
    buffer_load_dwordx4 v[12:15], v3, s[16:19], 0 offen offset:1024
    buffer_load_dwordx4 v[32:35], v2, s[20:23], 0 offen
    buffer_load_dwordx4 v[36:39], v2, s[20:23], 0 offen offset:1024
    v_lshlrev_b32 v3, 2, v1
    s_waitcnt vmcnt(0)
    v_lshlrev_b32 v16, 16, v8
    v_and_b32 v17, 0xffff0000, v8
    v_lshlrev_b32 v4, 16, v32
    v_and_b32 v5, 0xffff0000, v32
    v_mul_f32 v16, v16, v4
    v_mul_f32 v17, v17, v5
    v_cvt_pk_bf16_f32 v4, v16, v17
    v_lshlrev_b32 v16, 16, v4
    v_and_b32 v17, 0xffff0000, v4
    v_lshlrev_b32 v18, 16, v9
    v_and_b32 v19, 0xffff0000, v9
    v_lshlrev_b32 v4, 16, v33
    v_and_b32 v5, 0xffff0000, v33
    v_mul_f32 v18, v18, v4
    v_mul_f32 v19, v19, v5
    v_cvt_pk_bf16_f32 v4, v18, v19
    v_lshlrev_b32 v18, 16, v4
    v_and_b32 v19, 0xffff0000, v4
    v_lshlrev_b32 v20, 16, v10
    v_and_b32 v21, 0xffff0000, v10
    v_lshlrev_b32 v4, 16, v34
    v_and_b32 v5, 0xffff0000, v34
    v_mul_f32 v20, v20, v4
    v_mul_f32 v21, v21, v5
    v_cvt_pk_bf16_f32 v4, v20, v21
    v_lshlrev_b32 v20, 16, v4
    v_and_b32 v21, 0xffff0000, v4
    v_lshlrev_b32 v22, 16, v11
    v_and_b32 v23, 0xffff0000, v11
    v_lshlrev_b32 v4, 16, v35
    v_and_b32 v5, 0xffff0000, v35
    v_mul_f32 v22, v22, v4
    v_mul_f32 v23, v23, v5
    v_cvt_pk_bf16_f32 v4, v22, v23
    v_lshlrev_b32 v22, 16, v4
    v_and_b32 v23, 0xffff0000, v4
    v_lshlrev_b32 v24, 16, v12
    v_and_b32 v25, 0xffff0000, v12
    v_lshlrev_b32 v4, 16, v36
    v_and_b32 v5, 0xffff0000, v36
    v_mul_f32 v24, v24, v4
    v_mul_f32 v25, v25, v5
    v_cvt_pk_bf16_f32 v4, v24, v25
    v_lshlrev_b32 v24, 16, v4
    v_and_b32 v25, 0xffff0000, v4
    v_lshlrev_b32 v26, 16, v13
    v_and_b32 v27, 0xffff0000, v13
    v_lshlrev_b32 v4, 16, v37
    v_and_b32 v5, 0xffff0000, v37
    v_mul_f32 v26, v26, v4
    v_mul_f32 v27, v27, v5
    v_cvt_pk_bf16_f32 v4, v26, v27
    v_lshlrev_b32 v26, 16, v4
    v_and_b32 v27, 0xffff0000, v4
    v_lshlrev_b32 v28, 16, v14
    v_and_b32 v29, 0xffff0000, v14
    v_lshlrev_b32 v4, 16, v38
    v_and_b32 v5, 0xffff0000, v38
    v_mul_f32 v28, v28, v4
    v_mul_f32 v29, v29, v5
    v_cvt_pk_bf16_f32 v4, v28, v29
    v_lshlrev_b32 v28, 16, v4
    v_and_b32 v29, 0xffff0000, v4
    v_lshlrev_b32 v30, 16, v15
    v_and_b32 v31, 0xffff0000, v15
    v_lshlrev_b32 v4, 16, v39
    v_and_b32 v5, 0xffff0000, v39
    v_mul_f32 v30, v30, v4
    v_mul_f32 v31, v31, v5
    v_cvt_pk_bf16_f32 v4, v30, v31
    v_lshlrev_b32 v30, 16, v4
    v_and_b32 v31, 0xffff0000, v4
    v_add_f32 v4, v16, v17
    v_add_f32 v4, v4, v18
    v_add_f32 v4, v4, v19
    v_add_f32 v4, v4, v20
    v_add_f32 v4, v4, v21
    v_add_f32 v4, v4, v22
    v_add_f32 v4, v4, v23
    v_add_f32 v4, v4, v24
    v_add_f32 v4, v4, v25
    v_add_f32 v4, v4, v26
    v_add_f32 v4, v4, v27
    v_add_f32 v4, v4, v28
    v_add_f32 v4, v4, v29
    v_add_f32 v4, v4, v30
    v_add_f32 v4, v4, v31
    v_xor_b32 v5, 4, v3
    ds_bpermute_b32 v5, v5, v4
    s_waitcnt lgkmcnt(0)
    v_add_f32 v4, v4, v5
    v_xor_b32 v5, 8, v3
    ds_bpermute_b32 v5, v5, v4
    s_waitcnt lgkmcnt(0)
    v_add_f32 v4, v4, v5
    v_xor_b32 v5, 16, v3
    ds_bpermute_b32 v5, v5, v4
    s_waitcnt lgkmcnt(0)
    v_add_f32 v4, v4, v5
    v_xor_b32 v5, 32, v3
    ds_bpermute_b32 v5, v5, v4
    s_waitcnt lgkmcnt(0)
    v_add_f32 v4, v4, v5
    v_xor_b32 v5, 64, v3
    ds_bpermute_b32 v5, v5, v4
    s_waitcnt lgkmcnt(0)
    v_add_f32 v4, v4, v5
    v_xor_b32 v5, 128, v3
    ds_bpermute_b32 v5, v5, v4
    s_waitcnt lgkmcnt(0)
    v_add_f32 v4, v4, v5
    v_cvt_pk_bf16_f32 v4, v4, v4
    v_lshlrev_b32 v4, 16, v4
    v_mul_f32 v4, 0xbfb8aa3b, v4
    v_exp_f32 v4, v4
    s_nop 0
    v_add_f32 v4, 1.0, v4
    v_rcp_f32 v4, v4
    s_nop 0
    v_cvt_pk_bf16_f32 v4, v4, v4
    v_lshlrev_b32 v4, 16, v4
    v_cmp_eq_u32 vcc, 0, v1
    s_and_saveexec_b64 s[42:43], vcc
    s_lshl_b32 s40, s13, 2
    v_mov_b32 v5, s40
    buffer_store_dword v4, v5, s[24:27], 0 offen
END_prep_kernel_1:
    s_endpgm
.globl gemm1_kernel
.p2align 8
.type gemm1_kernel,@function
gemm1_kernel:
    s_cmp_ge_u32 s2, 256
    s_cbranch_scc1 END_gemm1_kernel_1
    v_lshrrev_b32 v1, 6, v0
    s_nop 0
    v_readfirstlane_b32 s30, v1
    s_load_dwordx2 s[44:45], s[0:1], 0
    s_load_dwordx2 s[46:47], s[0:1], 8
    s_load_dwordx2 s[48:49], s[0:1], 96
    s_load_dwordx2 s[50:51], s[0:1], 40
    s_load_dwordx2 s[74:75], s[0:1], 56
    s_load_dwordx2 s[76:77], s[0:1], 48
    s_waitcnt lgkmcnt(0)
    s_and_b32 s28, s2, 1
    s_lshl_b32 s28, s28, 2
    s_bfe_u32 s38, s2, 0x20003
    s_add_u32 s28, s28, s38
    s_lshl_b32 s28, s28, 8
    s_bfe_u32 s39, s2, 0x20001
    s_lshl_b32 s39, s39, 3
    s_lshr_b32 s38, s2, 5
    s_add_u32 s39, s39, s38
    s_cmp_ge_u32 s39, 24
    s_cbranch_scc1 PB_gemm1_kernel_2
    s_add_u32 s4, s44, 0x0
    s_addc_u32 s5, s45, 0
    s_mov_b32 s6, 0x400000
    s_mov_b32 s7, 0x00020000
    s_add_u32 s8, s46, 0x0
    s_addc_u32 s9, s47, 0
    s_mov_b32 s10, 0x600000
    s_mov_b32 s11, 0x00020000
    s_add_u32 s12, s48, 0x400000
    s_addc_u32 s13, s49, 0
    s_mov_b32 s14, 0xc00000
    s_mov_b32 s15, 0x00020000
    s_mov_b32 s24, 2048
    s_mov_b32 s25, 6144
    s_mov_b32 s26, 6144
    s_mov_b32 s41, 0
    s_branch GO_gemm1_kernel_3
PB_gemm1_kernel_2:
    s_add_u32 s4, s48, 0x0
    s_addc_u32 s5, s49, 0
    s_mov_b32 s6, 0x400000
    s_mov_b32 s7, 0x00020000
    s_add_u32 s8, s50, 0x0
    s_addc_u32 s9, s51, 0
    s_mov_b32 s10, 0x200000
    s_mov_b32 s11, 0x00020000
    s_add_u32 s12, s48, 0x1000000
    s_addc_u32 s13, s49, 0
    s_mov_b32 s14, 0x400000
    s_mov_b32 s15, 0x00020000
    s_mov_b32 s24, 2048
    s_mov_b32 s25, 2048
    s_mov_b32 s26, 2048
    s_mov_b32 s41, 1
    s_sub_u32 s39, s39, 24
GO_gemm1_kernel_3:
    s_mov_b32 s27, 16
    s_lshl_b32 s29, s39, 7
    s_add_u32 s64, s74, 0x0
    s_addc_u32 s65, s75, 0
    s_mov_b32 s66, 0x700000
    s_mov_b32 s67, 0x00020000
    s_add_u32 s68, s76, 0x0
    s_addc_u32 s69, s77, 0
    s_mov_b32 s70, 0x200000
    s_mov_b32 s71, 0x00020000
    v_and_b32 v8, 63, v0
    v_cmp_gt_u32 vcc, 2, v8
    v_lshlrev_b32 v8, 7, v8
    v_mov_b32 v9, 0x7ffffff0
    v_cndmask_b32 v8, v9, v8, vcc
    s_mul_i32 s72, s2, 8
    s_add_u32 s72, s72, s30
    s_mul_i32 s72, s72, s27
    s_lshl_b32 s72, s72, 8
    v_and_b32 v1, 63, v0
    v_lshrrev_b32 v2, 3, v1
    s_mul_i32 s38, s30, 32
    v_add_u32 v2, s38, v2
    v_mul_lo_u32 v2, v2, s24
    v_and_b32 v3, 7, v1
    v_lshrrev_b32 v4, 4, v1
    v_xor_b32 v3, v3, v4
    s_mul_i32 s38, s30, 4
    s_add_u32 s38, s38, 0
    s_and_b32 s38, s38, 1
    s_lshl_b32 s38, s38, 2
    v_xor_b32 v4, s38, v3
    v_lshl_add_u32 v16, v4, 4, v2
    s_lshl_b32 s38, s24, 3
    v_add_u32 v2, s38, v2
    s_mul_i32 s38, s30, 4
    s_add_u32 s38, s38, 1
    s_and_b32 s38, s38, 1
    s_lshl_b32 s38, s38, 2
    v_xor_b32 v4, s38, v3
    v_lshl_add_u32 v17, v4, 4, v2
    s_lshl_b32 s38, s24, 3
    v_add_u32 v2, s38, v2
    s_mul_i32 s38, s30, 4
    s_add_u32 s38, s38, 2
    s_and_b32 s38, s38, 1
    s_lshl_b32 s38, s38, 2
    v_xor_b32 v4, s38, v3
    v_lshl_add_u32 v18, v4, 4, v2
    s_lshl_b32 s38, s24, 3
    v_add_u32 v2, s38, v2
    s_mul_i32 s38, s30, 4
    s_add_u32 s38, s38, 3
    s_and_b32 s38, s38, 1
    s_lshl_b32 s38, s38, 2
    v_xor_b32 v4, s38, v3
    v_lshl_add_u32 v19, v4, 4, v2
    v_lshrrev_b32 v2, 4, v1
    s_mul_i32 s38, s30, 8
    v_add_u32 v3, s38, v2
    v_mul_lo_u32 v3, v3, s25
    v_lshlrev_b32 v2, 2, v2
    v_and_b32 v4, 15, v1
    v_xor_b32 v4, v4, v2
    v_lshl_add_u32 v20, v4, 4, v3
    s_lshl_b32 s38, s25, 2
    v_add_u32 v3, s38, v3
    v_lshl_add_u32 v21, v4, 4, v3
    s_mul_i32 s36, s30, 4096
    s_mul_i32 s37, s30, 2048
    s_add_u32 s37, s37, 32768
    s_mul_i32 s32, s28, s24
    s_lshl_b32 s33, s29, 1
    s_lshl_b32 s42, s25, 6
    s_mov_b32 s31, 0
    s_mov_b32 s35, 0
    s_add_u32 m0, s35, s36
    s_nop 0
    buffer_load_dwordx4 v16, s[4:7], s32 offen lds
    s_add_u32 m0, m0, 1024
    s_nop 0
    buffer_load_dwordx4 v17, s[4:7], s32 offen lds
    s_add_u32 m0, m0, 1024
    s_nop 0
    buffer_load_dwordx4 v18, s[4:7], s32 offen lds
    s_add_u32 m0, m0, 1024
    s_nop 0
    buffer_load_dwordx4 v19, s[4:7], s32 offen lds
    s_add_u32 m0, s35, s37
    s_nop 0
    buffer_load_dwordx4 v20, s[8:11], s33 offen lds
    s_add_u32 m0, m0, 1024
    s_nop 0
    buffer_load_dwordx4 v21, s[8:11], s33 offen lds
    buffer_load_dword v9, v8, s[64:67], s72 offen
    buffer_load_dword v9, v8, s[68:71], s72 offen
    s_add_u32 s72, s72, 256
    s_add_u32 s32, s32, 128
    s_add_u32 s33, s33, s42
    s_add_u32 s31, s31, 1
    s_mov_b32 s35, 49152
    s_add_u32 m0, s35, s36
    s_nop 0
    buffer_load_dwordx4 v16, s[4:7], s32 offen lds
    s_add_u32 m0, m0, 1024
    s_nop 0
    buffer_load_dwordx4 v17, s[4:7], s32 offen lds
    s_add_u32 m0, m0, 1024
    s_nop 0
    buffer_load_dwordx4 v18, s[4:7], s32 offen lds
    s_add_u32 m0, m0, 1024
    s_nop 0
    buffer_load_dwordx4 v19, s[4:7], s32 offen lds
    s_add_u32 m0, s35, s37
    s_nop 0
    buffer_load_dwordx4 v20, s[8:11], s33 offen lds
    s_add_u32 m0, m0, 1024
    s_nop 0
    buffer_load_dwordx4 v21, s[8:11], s33 offen lds
    buffer_load_dword v9, v8, s[64:67], s72 offen
    buffer_load_dword v9, v8, s[68:71], s72 offen
    s_add_u32 s72, s72, 256
    s_add_u32 s32, s32, 128
    s_add_u32 s33, s33, s42
    s_add_u32 s31, s31, 1
    s_mov_b32 s79, s42
    v_and_b32 v1, 63, v0
    s_and_b32 s42, s30, 3
    s_lshr_b32 s43, s30, 2
    v_and_b32 v2, 31, v1
    s_mul_i32 s38, s42, 64
    v_add_u32 v2, s38, v2
    v_lshlrev_b32 v2, 7, v2
    v_lshrrev_b32 v3, 5, v1
    v_bfe_u32 v4, v1, 1, 3
    v_xor_b32 v3, v3, v4
    v_xor_b32 v4, 0, v3
    v_lshl_add_u32 v10, v4, 4, v2
    v_xor_b32 v4, 2, v3
    v_lshl_add_u32 v11, v4, 4, v2
    v_xor_b32 v4, 4, v3
    v_lshl_add_u32 v12, v4, 4, v2
    v_xor_b32 v4, 6, v3
    v_lshl_add_u32 v13, v4, 4, v2
    v_bfe_u32 v2, v1, 2, 2
    v_lshrrev_b32 v3, 5, v1
    v_lshl_add_u32 v3, v3, 3, v2
    v_mul_u32_u24 v3, 256, v3
    v_bfe_u32 v4, v1, 4, 1
    v_lshl_add_u32 v3, v4, 5, v3
    v_and_b32 v4, 3, v1
    v_lshl_add_u32 v3, v4, 3, v3
    v_add_u32 v3, 32768, v3
    s_mul_i32 s38, s43, 2
    s_add_u32 s38, s38, 0
    v_xor_b32 v4, s38, v2
    v_lshl_add_u32 v14, v4, 6, v3
    s_mul_i32 s38, s43, 2
    s_add_u32 s38, s38, 1
    v_xor_b32 v4, s38, v2
    v_lshl_add_u32 v15, v4, 6, v3
    s_mov_b32 s42, s79
    v_mov_b32 v96, 0
    v_mov_b32 v97, 0
    v_mov_b32 v98, 0
    v_mov_b32 v99, 0
    v_mov_b32 v100, 0
    v_mov_b32 v101, 0
    v_mov_b32 v102, 0
    v_mov_b32 v103, 0
    v_mov_b32 v104, 0
    v_mov_b32 v105, 0
    v_mov_b32 v106, 0
    v_mov_b32 v107, 0
    v_mov_b32 v108, 0
    v_mov_b32 v109, 0
    v_mov_b32 v110, 0
    v_mov_b32 v111, 0
    v_mov_b32 v112, 0
    v_mov_b32 v113, 0
    v_mov_b32 v114, 0
    v_mov_b32 v115, 0
    v_mov_b32 v116, 0
    v_mov_b32 v117, 0
    v_mov_b32 v118, 0
    v_mov_b32 v119, 0
    v_mov_b32 v120, 0
    v_mov_b32 v121, 0
    v_mov_b32 v122, 0
    v_mov_b32 v123, 0
    v_mov_b32 v124, 0
    v_mov_b32 v125, 0
    v_mov_b32 v126, 0
    v_mov_b32 v127, 0
    v_mov_b32 v128, 0
    v_mov_b32 v129, 0
    v_mov_b32 v130, 0
    v_mov_b32 v131, 0
    v_mov_b32 v132, 0
    v_mov_b32 v133, 0
    v_mov_b32 v134, 0
    v_mov_b32 v135, 0
    v_mov_b32 v136, 0
    v_mov_b32 v137, 0
    v_mov_b32 v138, 0
    v_mov_b32 v139, 0
    v_mov_b32 v140, 0
    v_mov_b32 v141, 0
    v_mov_b32 v142, 0
    v_mov_b32 v143, 0
    v_mov_b32 v144, 0
    v_mov_b32 v145, 0
    v_mov_b32 v146, 0
    v_mov_b32 v147, 0
    v_mov_b32 v148, 0
    v_mov_b32 v149, 0
    v_mov_b32 v150, 0
    v_mov_b32 v151, 0
    v_mov_b32 v152, 0
    v_mov_b32 v153, 0
    v_mov_b32 v154, 0
    v_mov_b32 v155, 0
    v_mov_b32 v156, 0
    v_mov_b32 v157, 0
    v_mov_b32 v158, 0
    v_mov_b32 v159, 0
    s_mov_b32 s35, 98304
    s_mov_b32 s34, 0
    s_mov_b32 s43, 0
    s_waitcnt vmcnt(8)
    s_barrier
    s_cmp_ge_u32 s30, 4
    s_cbranch_scc1 GRPB_gemm1_kernel_4
PPL_gemm1_kernel_6:
    ds_read_b128 v[24:27], v10 offset:0
    ds_read_b128 v[40:43], v10 offset:4096
    ds_read_b64_tr_b16 v[56:57], v14 offset:0
    ds_read_b64_tr_b16 v[58:59], v14 offset:1024
    ds_read_b64_tr_b16 v[72:73], v15 offset:0
    ds_read_b64_tr_b16 v[74:75], v15 offset:1024
    ds_read_b128 v[28:31], v11 offset:0
    ds_read_b128 v[44:47], v11 offset:4096
    ds_read_b64_tr_b16 v[60:61], v14 offset:4096
    ds_read_b64_tr_b16 v[62:63], v14 offset:5120
    ds_read_b64_tr_b16 v[76:77], v15 offset:4096
    ds_read_b64_tr_b16 v[78:79], v15 offset:5120
    ds_read_b128 v[32:35], v12 offset:0
    ds_read_b128 v[48:51], v12 offset:4096
    ds_read_b64_tr_b16 v[64:65], v14 offset:8192
    ds_read_b64_tr_b16 v[66:67], v14 offset:9216
    ds_read_b64_tr_b16 v[80:81], v15 offset:8192
    ds_read_b64_tr_b16 v[82:83], v15 offset:9216
    ds_read_b128 v[36:39], v13 offset:0
    ds_read_b128 v[52:55], v13 offset:4096
    ds_read_b64_tr_b16 v[68:69], v14 offset:12288
    ds_read_b64_tr_b16 v[70:71], v14 offset:13312
    ds_read_b64_tr_b16 v[84:85], v15 offset:12288
    ds_read_b64_tr_b16 v[86:87], v15 offset:13312
    s_cmp_ge_u32 s31, s27
    s_cbranch_scc1 PPN_gemm1_kernel_7
    s_add_u32 m0, s35, s36
    s_nop 0
    buffer_load_dwordx4 v16, s[4:7], s32 offen lds
    s_add_u32 m0, m0, 1024
    s_nop 0
    buffer_load_dwordx4 v17, s[4:7], s32 offen lds
    s_add_u32 m0, m0, 1024
    s_nop 0
    buffer_load_dwordx4 v18, s[4:7], s32 offen lds
    s_add_u32 m0, m0, 1024
    s_nop 0
    buffer_load_dwordx4 v19, s[4:7], s32 offen lds
    s_add_u32 m0, s35, s37
    s_nop 0
    buffer_load_dwordx4 v20, s[8:11], s33 offen lds
    s_add_u32 m0, m0, 1024
    s_nop 0
    buffer_load_dwordx4 v21, s[8:11], s33 offen lds
    buffer_load_dword v9, v8, s[64:67], s72 offen
    buffer_load_dword v9, v8, s[68:71], s72 offen
    s_add_u32 s72, s72, 256
    s_add_u32 s32, s32, 128
    s_add_u32 s33, s33, s42
    s_add_u32 s31, s31, 1
PPN_gemm1_kernel_7:
    s_waitcnt lgkmcnt(0)
    s_barrier
    s_setprio 1
    v_mfma_f32_32x32x16_bf16 v[96:111], v[56:59], v[24:27], v[96:111]
    v_mfma_f32_32x32x16_bf16 v[112:127], v[56:59], v[40:43], v[112:127]
    v_mfma_f32_32x32x16_bf16 v[128:143], v[72:75], v[24:27], v[128:143]
    v_mfma_f32_32x32x16_bf16 v[144:159], v[72:75], v[40:43], v[144:159]
    v_mfma_f32_32x32x16_bf16 v[96:111], v[60:63], v[28:31], v[96:111]
    v_mfma_f32_32x32x16_bf16 v[112:127], v[60:63], v[44:47], v[112:127]
    v_mfma_f32_32x32x16_bf16 v[128:143], v[76:79], v[28:31], v[128:143]
    v_mfma_f32_32x32x16_bf16 v[144:159], v[76:79], v[44:47], v[144:159]
    v_mfma_f32_32x32x16_bf16 v[96:111], v[64:67], v[32:35], v[96:111]
    v_mfma_f32_32x32x16_bf16 v[112:127], v[64:67], v[48:51], v[112:127]
    v_mfma_f32_32x32x16_bf16 v[128:143], v[80:83], v[32:35], v[128:143]
    v_mfma_f32_32x32x16_bf16 v[144:159], v[80:83], v[48:51], v[144:159]
    v_mfma_f32_32x32x16_bf16 v[96:111], v[68:71], v[36:39], v[96:111]
    v_mfma_f32_32x32x16_bf16 v[112:127], v[68:71], v[52:55], v[112:127]
    v_mfma_f32_32x32x16_bf16 v[128:143], v[84:87], v[36:39], v[128:143]
    v_mfma_f32_32x32x16_bf16 v[144:159], v[84:87], v[52:55], v[144:159]
    s_setprio 0
    s_mov_b32 s39, s34
    s_add_u32 s34, s34, 49152
    s_cmp_eq_u32 s34, 147456
    s_cselect_b32 s34, 0, s34
    s_sub_u32 s38, s34, s39
    v_add_u32 v10, s38, v10
    v_add_u32 v11, s38, v11
    v_add_u32 v12, s38, v12
    v_add_u32 v13, s38, v13
    v_add_u32 v14, s38, v14
    v_add_u32 v15, s38, v15
    s_add_u32 s35, s35, 49152
    s_cmp_eq_u32 s35, 147456
    s_cselect_b32 s35, 0, s35
    s_add_u32 s43, s43, 1
    s_add_u32 s38, s43, 2
    s_cmp_eq_u32 s38, s31
    s_cbranch_scc1 PX0_gemm1_kernel_10
    s_waitcnt vmcnt(0)
    s_branch PX1_gemm1_kernel_11
PX0_gemm1_kernel_10:
    s_waitcnt vmcnt(8)
PX1_gemm1_kernel_11:
    s_barrier
    s_cmp_lt_u32 s43, s27
    s_cbranch_scc1 PPL_gemm1_kernel_6
    s_barrier
    s_branch PPD_gemm1_kernel_5
GRPB_gemm1_kernel_4:
    s_barrier
PPL_gemm1_kernel_12:
    ds_read_b128 v[24:27], v10 offset:0
    ds_read_b128 v[40:43], v10 offset:4096
    ds_read_b64_tr_b16 v[56:57], v14 offset:0
    ds_read_b64_tr_b16 v[58:59], v14 offset:1024
    ds_read_b64_tr_b16 v[72:73], v15 offset:0
    ds_read_b64_tr_b16 v[74:75], v15 offset:1024
    ds_read_b128 v[28:31], v11 offset:0
    ds_read_b128 v[44:47], v11 offset:4096
    ds_read_b64_tr_b16 v[60:61], v14 offset:4096
    ds_read_b64_tr_b16 v[62:63], v14 offset:5120
    ds_read_b64_tr_b16 v[76:77], v15 offset:4096
    ds_read_b64_tr_b16 v[78:79], v15 offset:5120
    ds_read_b128 v[32:35], v12 offset:0
    ds_read_b128 v[48:51], v12 offset:4096
    ds_read_b64_tr_b16 v[64:65], v14 offset:8192
    ds_read_b64_tr_b16 v[66:67], v14 offset:9216
    ds_read_b64_tr_b16 v[80:81], v15 offset:8192
    ds_read_b64_tr_b16 v[82:83], v15 offset:9216
    ds_read_b128 v[36:39], v13 offset:0
    ds_read_b128 v[52:55], v13 offset:4096
    ds_read_b64_tr_b16 v[68:69], v14 offset:12288
    ds_read_b64_tr_b16 v[70:71], v14 offset:13312
    ds_read_b64_tr_b16 v[84:85], v15 offset:12288
    ds_read_b64_tr_b16 v[86:87], v15 offset:13312
    s_cmp_ge_u32 s31, s27
    s_cbranch_scc1 PPN_gemm1_kernel_13
    s_add_u32 m0, s35, s36
    s_nop 0
    buffer_load_dwordx4 v16, s[4:7], s32 offen lds
    s_add_u32 m0, m0, 1024
    s_nop 0
    buffer_load_dwordx4 v17, s[4:7], s32 offen lds
    s_add_u32 m0, m0, 1024
    s_nop 0
    buffer_load_dwordx4 v18, s[4:7], s32 offen lds
    s_add_u32 m0, m0, 1024
    s_nop 0
    buffer_load_dwordx4 v19, s[4:7], s32 offen lds
    s_add_u32 m0, s35, s37
    s_nop 0
    buffer_load_dwordx4 v20, s[8:11], s33 offen lds
    s_add_u32 m0, m0, 1024
    s_nop 0
    buffer_load_dwordx4 v21, s[8:11], s33 offen lds
    buffer_load_dword v9, v8, s[64:67], s72 offen
    buffer_load_dword v9, v8, s[68:71], s72 offen
    s_add_u32 s72, s72, 256
    s_add_u32 s32, s32, 128
    s_add_u32 s33, s33, s42
    s_add_u32 s31, s31, 1
PPN_gemm1_kernel_13:
    s_add_u32 s38, s43, 3
    s_cmp_eq_u32 s38, s31
    s_cbranch_scc1 PW0_gemm1_kernel_14
    s_waitcnt vmcnt(0) lgkmcnt(0)
    s_branch PW1_gemm1_kernel_15
PW0_gemm1_kernel_14:
    s_waitcnt vmcnt(8) lgkmcnt(0)
PW1_gemm1_kernel_15:
    s_barrier
    s_setprio 1
    v_mfma_f32_32x32x16_bf16 v[96:111], v[56:59], v[24:27], v[96:111]
    v_mfma_f32_32x32x16_bf16 v[112:127], v[56:59], v[40:43], v[112:127]
    v_mfma_f32_32x32x16_bf16 v[128:143], v[72:75], v[24:27], v[128:143]
    v_mfma_f32_32x32x16_bf16 v[144:159], v[72:75], v[40:43], v[144:159]
    v_mfma_f32_32x32x16_bf16 v[96:111], v[60:63], v[28:31], v[96:111]
    v_mfma_f32_32x32x16_bf16 v[112:127], v[60:63], v[44:47], v[112:127]
    v_mfma_f32_32x32x16_bf16 v[128:143], v[76:79], v[28:31], v[128:143]
    v_mfma_f32_32x32x16_bf16 v[144:159], v[76:79], v[44:47], v[144:159]
    v_mfma_f32_32x32x16_bf16 v[96:111], v[64:67], v[32:35], v[96:111]
    v_mfma_f32_32x32x16_bf16 v[112:127], v[64:67], v[48:51], v[112:127]
    v_mfma_f32_32x32x16_bf16 v[128:143], v[80:83], v[32:35], v[128:143]
    v_mfma_f32_32x32x16_bf16 v[144:159], v[80:83], v[48:51], v[144:159]
    v_mfma_f32_32x32x16_bf16 v[96:111], v[68:71], v[36:39], v[96:111]
    v_mfma_f32_32x32x16_bf16 v[112:127], v[68:71], v[52:55], v[112:127]
    v_mfma_f32_32x32x16_bf16 v[128:143], v[84:87], v[36:39], v[128:143]
    v_mfma_f32_32x32x16_bf16 v[144:159], v[84:87], v[52:55], v[144:159]
    s_setprio 0
    s_mov_b32 s39, s34
    s_add_u32 s34, s34, 49152
    s_cmp_eq_u32 s34, 147456
    s_cselect_b32 s34, 0, s34
    s_sub_u32 s38, s34, s39
    v_add_u32 v10, s38, v10
    v_add_u32 v11, s38, v11
    v_add_u32 v12, s38, v12
    v_add_u32 v13, s38, v13
    v_add_u32 v14, s38, v14
    v_add_u32 v15, s38, v15
    s_add_u32 s35, s35, 49152
    s_cmp_eq_u32 s35, 147456
    s_cselect_b32 s35, 0, s35
    s_add_u32 s43, s43, 1
    s_barrier
    s_cmp_lt_u32 s43, s27
    s_cbranch_scc1 PPL_gemm1_kernel_12
PPD_gemm1_kernel_5:
    s_sub_u32 s38, 0, s34
    v_add_u32 v10, s38, v10
    v_add_u32 v11, s38, v11
    v_add_u32 v12, s38, v12
    v_add_u32 v13, s38, v13
    v_add_u32 v14, s38, v14
    v_add_u32 v15, s38, v15
    s_cmp_eq_u32 s41, 1
    s_cbranch_scc1 EG_gemm1_kernel_18
    v_and_b32 v1, 63, v0
    v_lshrrev_b32 v2, 4, v1
    s_mul_i32 s38, s30, 32
    v_add_u32 v2, s38, v2
    v_and_b32 v3, 15, v1
    v_and_b32 v4, 7, v2
    v_lshlrev_b32 v5, 1, v3
    v_xor_b32 v4, v4, v5
    v_mul_u32_u24 v5, 512, v2
    v_lshl_add_u32 v5, v4, 4, v5
    v_add_u32 v4, s28, v2
    v_mul_lo_u32 v6, v4, s26
    v_lshl_add_u32 v6, v3, 4, v6
    s_lshl_b32 s38, s29, 1
    v_add_u32 v6, s38, v6
    v_lshlrev_b32 v7, 2, v4
    s_nop 15
    s_nop 7
    s_and_b32 s42, s30, 3
    s_lshr_b32 s43, s30, 2
    v_and_b32 v1, 31, v0
    s_mul_i32 s38, s42, 64
    v_add_u32 v1, s38, v1
    v_mul_u32_u24 v2, 512, v1
    v_and_b32 v1, 7, v0
    v_bfe_u32 v3, v0, 5, 1
    v_xor_b32 v1, v1, v3
    s_mul_i32 s38, s43, 16
    v_xor_b32 v1, s38, v1
    v_lshl_add_u32 v2, v1, 4, v2
    v_xor_b32 v1, 0, v2
    ds_write_b128 v1, v[96:99] offset:0
    v_xor_b32 v1, 32, v2
    ds_write_b128 v1, v[100:103] offset:0
    v_xor_b32 v1, 64, v2
    ds_write_b128 v1, v[104:107] offset:0
    v_xor_b32 v1, 96, v2
    ds_write_b128 v1, v[108:111] offset:0
    v_xor_b32 v1, 128, v2
    ds_write_b128 v1, v[128:131] offset:0
    v_xor_b32 v1, 160, v2
    ds_write_b128 v1, v[132:135] offset:0
    v_xor_b32 v1, 192, v2
    ds_write_b128 v1, v[136:139] offset:0
    v_xor_b32 v1, 224, v2
    ds_write_b128 v1, v[140:143] offset:0
    v_xor_b32 v1, 0, v2
    ds_write_b128 v1, v[112:115] offset:16384
    v_xor_b32 v1, 32, v2
    ds_write_b128 v1, v[116:119] offset:16384
    v_xor_b32 v1, 64, v2
    ds_write_b128 v1, v[120:123] offset:16384
    v_xor_b32 v1, 96, v2
    ds_write_b128 v1, v[124:127] offset:16384
    v_xor_b32 v1, 128, v2
    ds_write_b128 v1, v[144:147] offset:16384
    v_xor_b32 v1, 160, v2
    ds_write_b128 v1, v[148:151] offset:16384
    v_xor_b32 v1, 192, v2
    ds_write_b128 v1, v[152:155] offset:16384
    v_xor_b32 v1, 224, v2
    ds_write_b128 v1, v[156:159] offset:16384
    s_waitcnt lgkmcnt(0)
    s_barrier
    s_mov_b32 s39, 0
    s_mul_i32 s43, s26, 4
    s_mov_b32 s31, 8
EPL_gemm1_kernel_19:
    v_xor_b32 v1, 16, v5
    ds_read_b128 v[24:27], v5
    ds_read_b128 v[28:31], v1
    s_waitcnt lgkmcnt(0)
    v_cvt_pk_bf16_f32 v48, v24, v25
    v_cvt_pk_bf16_f32 v49, v26, v27
    v_cvt_pk_bf16_f32 v50, v28, v29
    v_cvt_pk_bf16_f32 v51, v30, v31
    buffer_store_dwordx4 v[48:51], v6, s[12:15], s39 offen
    v_add_u32 v5, 2048, v5
    v_xor_b32 v5, 64, v5
    s_add_u32 s39, s39, s43
    s_sub_u32 s31, s31, 1
    s_cmp_lg_u32 s31, 0
    s_cbranch_scc1 EPL_gemm1_kernel_19
    s_waitcnt vmcnt(0)
    s_endpgm
EG_gemm1_kernel_18:
    v_and_b32 v1, 63, v0
    v_lshrrev_b32 v2, 4, v1
    s_mul_i32 s38, s30, 32
    v_add_u32 v2, s38, v2
    v_and_b32 v3, 15, v1
    v_and_b32 v4, 7, v2
    v_lshlrev_b32 v5, 1, v3
    v_xor_b32 v4, v4, v5
    v_mul_u32_u24 v5, 512, v2
    v_lshl_add_u32 v5, v4, 4, v5
    v_add_u32 v4, s28, v2
    v_mul_lo_u32 v6, v4, s26
    v_lshl_add_u32 v6, v3, 4, v6
    s_lshl_b32 s38, s29, 1
    v_add_u32 v6, s38, v6
    v_lshlrev_b32 v7, 2, v4
    s_nop 15
    s_nop 7
    s_and_b32 s42, s30, 3
    s_lshr_b32 s43, s30, 2
    v_and_b32 v1, 31, v0
    s_mul_i32 s38, s42, 64
    v_add_u32 v1, s38, v1
    v_mul_u32_u24 v2, 512, v1
    v_and_b32 v1, 7, v0
    v_bfe_u32 v3, v0, 5, 1
    v_xor_b32 v1, v1, v3
    s_mul_i32 s38, s43, 16
    v_xor_b32 v1, s38, v1
    v_lshl_add_u32 v2, v1, 4, v2
    v_xor_b32 v1, 0, v2
    ds_write_b128 v1, v[96:99] offset:0
    v_xor_b32 v1, 32, v2
    ds_write_b128 v1, v[100:103] offset:0
    v_xor_b32 v1, 64, v2
    ds_write_b128 v1, v[104:107] offset:0
    v_xor_b32 v1, 96, v2
    ds_write_b128 v1, v[108:111] offset:0
    v_xor_b32 v1, 128, v2
    ds_write_b128 v1, v[128:131] offset:0
    v_xor_b32 v1, 160, v2
    ds_write_b128 v1, v[132:135] offset:0
    v_xor_b32 v1, 192, v2
    ds_write_b128 v1, v[136:139] offset:0
    v_xor_b32 v1, 224, v2
    ds_write_b128 v1, v[140:143] offset:0
    v_xor_b32 v1, 0, v2
    ds_write_b128 v1, v[112:115] offset:16384
    v_xor_b32 v1, 32, v2
    ds_write_b128 v1, v[116:119] offset:16384
    v_xor_b32 v1, 64, v2
    ds_write_b128 v1, v[120:123] offset:16384
    v_xor_b32 v1, 96, v2
    ds_write_b128 v1, v[124:127] offset:16384
    v_xor_b32 v1, 128, v2
    ds_write_b128 v1, v[144:147] offset:16384
    v_xor_b32 v1, 160, v2
    ds_write_b128 v1, v[148:151] offset:16384
    v_xor_b32 v1, 192, v2
    ds_write_b128 v1, v[152:155] offset:16384
    v_xor_b32 v1, 224, v2
    ds_write_b128 v1, v[156:159] offset:16384
    s_waitcnt lgkmcnt(0)
    s_barrier
    s_mov_b32 s39, 0
    s_mul_i32 s43, s26, 4
    v_mov_b32 v44, 0x3d372713
    v_mov_b32 v45, 0x3d372713
    v_mov_b32 v46, 0xc0135761
    v_mov_b32 v47, 0xc0135761
    s_mov_b32 s31, 8
EPL_gemm1_kernel_20:
    v_xor_b32 v1, 16, v5
    ds_read_b128 v[24:27], v5
    ds_read_b128 v[28:31], v1
    s_waitcnt lgkmcnt(0)
    v_cvt_pk_bf16_f32 v40, v24, v25
    v_lshlrev_b32 v24, 16, v40
    v_and_b32 v25, 0xffff0000, v40
    v_pk_mul_f32 v[40:41], v[24:25], v[24:25]
    v_pk_fma_f32 v[40:41], v[40:41], v[44:45], 1.0 op_sel_hi:[1,1,0]
    v_pk_mul_f32 v[40:41], v[40:41], v[24:25]
    v_pk_mul_f32 v[40:41], v[40:41], v[46:47]
    v_exp_f32 v40, v40
    v_exp_f32 v41, v41
    s_nop 0
    v_pk_add_f32 v[40:41], v[40:41], 1.0 op_sel_hi:[1,0]
    v_rcp_f32 v40, v40
    v_rcp_f32 v41, v41
    s_nop 0
    v_pk_mul_f32 v[24:25], v[24:25], v[40:41]
    v_cvt_pk_bf16_f32 v48, v24, v25
    v_cvt_pk_bf16_f32 v40, v26, v27
    v_lshlrev_b32 v26, 16, v40
    v_and_b32 v27, 0xffff0000, v40
    v_pk_mul_f32 v[40:41], v[26:27], v[26:27]
    v_pk_fma_f32 v[40:41], v[40:41], v[44:45], 1.0 op_sel_hi:[1,1,0]
    v_pk_mul_f32 v[40:41], v[40:41], v[26:27]
    v_pk_mul_f32 v[40:41], v[40:41], v[46:47]
    v_exp_f32 v40, v40
    v_exp_f32 v41, v41
    s_nop 0
    v_pk_add_f32 v[40:41], v[40:41], 1.0 op_sel_hi:[1,0]
    v_rcp_f32 v40, v40
    v_rcp_f32 v41, v41
    s_nop 0
    v_pk_mul_f32 v[26:27], v[26:27], v[40:41]
    v_cvt_pk_bf16_f32 v49, v26, v27
    v_cvt_pk_bf16_f32 v40, v28, v29
    v_lshlrev_b32 v28, 16, v40
    v_and_b32 v29, 0xffff0000, v40
    v_pk_mul_f32 v[40:41], v[28:29], v[28:29]
    v_pk_fma_f32 v[40:41], v[40:41], v[44:45], 1.0 op_sel_hi:[1,1,0]
    v_pk_mul_f32 v[40:41], v[40:41], v[28:29]
    v_pk_mul_f32 v[40:41], v[40:41], v[46:47]
    v_exp_f32 v40, v40
    v_exp_f32 v41, v41
    s_nop 0
    v_pk_add_f32 v[40:41], v[40:41], 1.0 op_sel_hi:[1,0]
    v_rcp_f32 v40, v40
    v_rcp_f32 v41, v41
    s_nop 0
    v_pk_mul_f32 v[28:29], v[28:29], v[40:41]
    v_cvt_pk_bf16_f32 v50, v28, v29
    v_cvt_pk_bf16_f32 v40, v30, v31
    v_lshlrev_b32 v30, 16, v40
    v_and_b32 v31, 0xffff0000, v40
    v_pk_mul_f32 v[40:41], v[30:31], v[30:31]
    v_pk_fma_f32 v[40:41], v[40:41], v[44:45], 1.0 op_sel_hi:[1,1,0]
    v_pk_mul_f32 v[40:41], v[40:41], v[30:31]
    v_pk_mul_f32 v[40:41], v[40:41], v[46:47]
    v_exp_f32 v40, v40
    v_exp_f32 v41, v41
    s_nop 0
    v_pk_add_f32 v[40:41], v[40:41], 1.0 op_sel_hi:[1,0]
    v_rcp_f32 v40, v40
    v_rcp_f32 v41, v41
    s_nop 0
    v_pk_mul_f32 v[30:31], v[30:31], v[40:41]
    v_cvt_pk_bf16_f32 v51, v30, v31
    buffer_store_dwordx4 v[48:51], v6, s[12:15], s39 offen
    v_add_u32 v5, 2048, v5
    v_xor_b32 v5, 64, v5
    s_add_u32 s39, s39, s43
    s_sub_u32 s31, s31, 1
    s_cmp_lg_u32 s31, 0
    s_cbranch_scc1 EPL_gemm1_kernel_20
END_gemm1_kernel_1:
    s_endpgm
.globl g2kv_kernel
.p2align 8
.type g2kv_kernel,@function
g2kv_kernel:
    s_cmp_ge_u32 s2, 256
    s_cbranch_scc1 BODY2_g2kv_kernel_1
    s_cmp_ge_u32 s2, 256
    s_cbranch_scc1 END_gemm2_kernel_1
    v_lshrrev_b32 v1, 6, v0
    s_nop 0
    v_readfirstlane_b32 s30, v1
    s_load_dwordx2 s[44:45], s[0:1], 0
    s_load_dwordx2 s[46:47], s[0:1], 48
    s_load_dwordx2 s[48:49], s[0:1], 96
    s_waitcnt lgkmcnt(0)
    s_add_u32 s4, s48, 0x1000000
    s_addc_u32 s5, s49, 0
    s_mov_b32 s6, 0x400000
    s_mov_b32 s7, 0x00020000
    s_add_u32 s8, s46, 0x0
    s_addc_u32 s9, s47, 0
    s_mov_b32 s10, 0x200000
    s_mov_b32 s11, 0x00020000
    s_add_u32 s12, s48, 0x1400000
    s_addc_u32 s13, s49, 0
    s_mov_b32 s14, 0x400000
    s_mov_b32 s15, 0x00020000
    s_add_u32 s16, s44, 0x0
    s_addc_u32 s17, s45, 0
    s_mov_b32 s18, 0x400000
    s_mov_b32 s19, 0x00020000
    s_mov_b32 s24, 2048
    s_mov_b32 s25, 2048
    s_mov_b32 s26, 2048
    s_mov_b32 s27, 16
    s_and_b32 s28, s2, 15
    s_lshl_b32 s28, s28, 7
    s_lshr_b32 s29, s2, 4
    s_lshl_b32 s29, s29, 6
    v_and_b32 v1, 63, v0
    v_lshrrev_b32 v2, 3, v1
    s_mul_i32 s38, s30, 32
    v_add_u32 v2, s38, v2
    v_mul_lo_u32 v2, v2, s24
    v_and_b32 v3, 7, v1
    v_lshrrev_b32 v4, 4, v1
    v_xor_b32 v3, v3, v4
    s_mul_i32 s38, s30, 4
    s_add_u32 s38, s38, 0
    s_and_b32 s38, s38, 1
    s_lshl_b32 s38, s38, 2
    v_xor_b32 v4, s38, v3
    v_lshl_add_u32 v15, v4, 4, v2
    s_lshl_b32 s38, s24, 3
    v_add_u32 v2, s38, v2
    s_mul_i32 s38, s30, 4
    s_add_u32 s38, s38, 1
    s_and_b32 s38, s38, 1
    s_lshl_b32 s38, s38, 2
    v_xor_b32 v4, s38, v3
    v_lshl_add_u32 v16, v4, 4, v2
    s_lshl_b32 s38, s24, 3
    v_add_u32 v2, s38, v2
    s_mul_i32 s38, s30, 4
    s_add_u32 s38, s38, 2
    s_and_b32 s38, s38, 1
    s_lshl_b32 s38, s38, 2
    v_xor_b32 v4, s38, v3
    v_lshl_add_u32 v17, v4, 4, v2
    s_lshl_b32 s38, s24, 3
    v_add_u32 v2, s38, v2
    s_mul_i32 s38, s30, 4
    s_add_u32 s38, s38, 3
    s_and_b32 s38, s38, 1
    s_lshl_b32 s38, s38, 2
    v_xor_b32 v4, s38, v3
    v_lshl_add_u32 v18, v4, 4, v2
    v_lshrrev_b32 v2, 3, v1
    s_mul_i32 s38, s30, 16
    v_add_u32 v3, s38, v2
    v_mul_lo_u32 v3, v3, s25
    v_lshrrev_b32 v2, 4, v1
    v_and_b32 v2, 1, v2
    v_lshlrev_b32 v2, 2, v2
    v_and_b32 v4, 7, v1
    v_xor_b32 v4, v4, v2
    v_lshl_add_u32 v19, v4, 4, v3
    s_lshl_b32 s38, s25, 3
    v_add_u32 v3, s38, v3
    v_lshl_add_u32 v20, v4, 4, v3
    s_mul_i32 s36, s30, 4096
    s_mul_i32 s37, s30, 2048
    s_add_u32 s37, s37, 16384
    s_and_b32 s42, s30, 1
    s_lshr_b32 s43, s30, 1
    v_and_b32 v2, 31, v1
    s_mul_i32 s38, s42, 64
    v_add_u32 v2, s38, v2
    v_lshlrev_b32 v2, 7, v2
    v_lshrrev_b32 v3, 5, v1
    v_bfe_u32 v4, v1, 1, 3
    v_xor_b32 v3, v3, v4
    v_xor_b32 v4, 0, v3
    v_lshl_add_u32 v10, v4, 4, v2
    v_xor_b32 v4, 2, v3
    v_lshl_add_u32 v11, v4, 4, v2
    v_xor_b32 v4, 4, v3
    v_lshl_add_u32 v12, v4, 4, v2
    v_xor_b32 v4, 6, v3
    v_lshl_add_u32 v13, v4, 4, v2
    v_bfe_u32 v2, v1, 2, 2
    v_lshrrev_b32 v3, 5, v1
    v_lshl_add_u32 v3, v3, 3, v2
    v_mul_u32_u24 v3, 128, v3
    v_bfe_u32 v4, v1, 4, 1
    v_lshl_add_u32 v3, v4, 5, v3
    v_and_b32 v4, 3, v1
    v_lshl_add_u32 v3, v4, 3, v3
    v_add_u32 v3, 16384, v3
    v_lshrrev_b32 v2, 1, v2
    s_mul_i32 s38, s43, 1
    s_add_u32 s38, s38, 0
    v_xor_b32 v4, s38, v2
    v_lshl_add_u32 v14, v4, 6, v3
    s_mov_b32 s32, 0
    s_lshl_b32 s33, s29, 1
    s_mov_b32 s34, 0
    s_lshl_b32 s42, s25, 6
    v_mov_b32 v64, 0
    v_mov_b32 v65, 0
    v_mov_b32 v66, 0
    v_mov_b32 v67, 0
    v_mov_b32 v68, 0
    v_mov_b32 v69, 0
    v_mov_b32 v70, 0
    v_mov_b32 v71, 0
    v_mov_b32 v72, 0
    v_mov_b32 v73, 0
    v_mov_b32 v74, 0
    v_mov_b32 v75, 0
    v_mov_b32 v76, 0
    v_mov_b32 v77, 0
    v_mov_b32 v78, 0
    v_mov_b32 v79, 0
    v_mov_b32 v80, 0
    v_mov_b32 v81, 0
    v_mov_b32 v82, 0
    v_mov_b32 v83, 0
    v_mov_b32 v84, 0
    v_mov_b32 v85, 0
    v_mov_b32 v86, 0
    v_mov_b32 v87, 0
    v_mov_b32 v88, 0
    v_mov_b32 v89, 0
    v_mov_b32 v90, 0
    v_mov_b32 v91, 0
    v_mov_b32 v92, 0
    v_mov_b32 v93, 0
    v_mov_b32 v94, 0
    v_mov_b32 v95, 0
    s_mov_b32 s31, 0
    s_lshr_b32 s38, s31, 2
    s_and_b32 s39, s38, 1
    s_lshr_b32 s38, s38, 1
    s_lshl_b32 s40, 2048, s38
    s_sub_u32 s38, 0, s40
    s_cmp_eq_u32 s39, 1
    s_cselect_b32 s40, s40, s38
    s_lshl_b32 s38, s28, 11
    s_add_u32 s40, s40, s38
    v_add_u32 v21, s40, v15
    v_add_u32 v22, s40, v16
    v_add_u32 v23, s40, v17
    v_add_u32 v24, s40, v18
    s_mov_b32 s35, 0
    s_add_u32 m0, s35, s36
    s_nop 0
    buffer_load_dwordx4 v21, s[4:7], s32 offen lds
    s_add_u32 m0, m0, 1024
    s_nop 0
    buffer_load_dwordx4 v22, s[4:7], s32 offen lds
    s_add_u32 m0, m0, 1024
    s_nop 0
    buffer_load_dwordx4 v23, s[4:7], s32 offen lds
    s_add_u32 m0, m0, 1024
    s_nop 0
    buffer_load_dwordx4 v24, s[4:7], s32 offen lds
    s_add_u32 m0, s35, s37
    s_nop 0
    buffer_load_dwordx4 v19, s[8:11], s33 offen lds
    s_add_u32 m0, m0, 1024
    s_nop 0
    buffer_load_dwordx4 v20, s[8:11], s33 offen lds
    s_add_u32 s32, s32, 128
    s_add_u32 s33, s33, s42
    s_add_u32 s31, s31, 1
    s_lshr_b32 s38, s31, 2
    s_and_b32 s39, s38, 1
    s_lshr_b32 s38, s38, 1
    s_lshl_b32 s40, 2048, s38
    s_sub_u32 s38, 0, s40
    s_cmp_eq_u32 s39, 1
    s_cselect_b32 s40, s40, s38
    s_lshl_b32 s38, s28, 11
    s_add_u32 s40, s40, s38
    v_add_u32 v21, s40, v15
    v_add_u32 v22, s40, v16
    v_add_u32 v23, s40, v17
    v_add_u32 v24, s40, v18
    s_mov_b32 s35, 24576
    s_add_u32 m0, s35, s36
    s_nop 0
    buffer_load_dwordx4 v21, s[4:7], s32 offen lds
    s_add_u32 m0, m0, 1024
    s_nop 0
    buffer_load_dwordx4 v22, s[4:7], s32 offen lds
    s_add_u32 m0, m0, 1024
    s_nop 0
    buffer_load_dwordx4 v23, s[4:7], s32 offen lds
    s_add_u32 m0, m0, 1024
    s_nop 0
    buffer_load_dwordx4 v24, s[4:7], s32 offen lds
    s_add_u32 m0, s35, s37
    s_nop 0
    buffer_load_dwordx4 v19, s[8:11], s33 offen lds
    s_add_u32 m0, m0, 1024
    s_nop 0
    buffer_load_dwordx4 v20, s[8:11], s33 offen lds
    s_add_u32 s32, s32, 128
    s_add_u32 s33, s33, s42
    s_add_u32 s31, s31, 1
    s_lshr_b32 s38, s31, 2
    s_and_b32 s39, s38, 1
    s_lshr_b32 s38, s38, 1
    s_lshl_b32 s40, 2048, s38
    s_sub_u32 s38, 0, s40
    s_cmp_eq_u32 s39, 1
    s_cselect_b32 s40, s40, s38
    s_lshl_b32 s38, s28, 11
    s_add_u32 s40, s40, s38
    v_add_u32 v21, s40, v15
    v_add_u32 v22, s40, v16
    v_add_u32 v23, s40, v17
    v_add_u32 v24, s40, v18
    s_mov_b32 s35, 49152
    s_add_u32 m0, s35, s36
    s_nop 0
    buffer_load_dwordx4 v21, s[4:7], s32 offen lds
    s_add_u32 m0, m0, 1024
    s_nop 0
    buffer_load_dwordx4 v22, s[4:7], s32 offen lds
    s_add_u32 m0, m0, 1024
    s_nop 0
    buffer_load_dwordx4 v23, s[4:7], s32 offen lds
    s_add_u32 m0, m0, 1024
    s_nop 0
    buffer_load_dwordx4 v24, s[4:7], s32 offen lds
    s_add_u32 m0, s35, s37
    s_nop 0
    buffer_load_dwordx4 v19, s[8:11], s33 offen lds
    s_add_u32 m0, m0, 1024
    s_nop 0
    buffer_load_dwordx4 v20, s[8:11], s33 offen lds
    s_add_u32 s32, s32, 128
    s_add_u32 s33, s33, s42
    s_add_u32 s31, s31, 1
    s_waitcnt vmcnt(12)
    s_barrier
    ds_read_b128 v[28:31], v10 offset:0
    ds_read_b128 v[32:35], v10 offset:4096
    ds_read_b64_tr_b16 v[36:37], v14 offset:0
    ds_read_b64_tr_b16 v[38:39], v14 offset:512
    s_mov_b32 s43, 0
KLOOP_gemm2_kernel_2:
    ds_read_b128 v[40:43], v11 offset:0
    ds_read_b128 v[44:47], v11 offset:4096
    ds_read_b64_tr_b16 v[48:49], v14 offset:2048
    ds_read_b64_tr_b16 v[50:51], v14 offset:2560
    s_waitcnt lgkmcnt(4)
    v_mfma_f32_32x32x16_bf16 v[64:79], v[36:39], v[28:31], v[64:79]
    v_mfma_f32_32x32x16_bf16 v[80:95], v[36:39], v[32:35], v[80:95]
    ds_read_b128 v[28:31], v12 offset:0
    ds_read_b128 v[32:35], v12 offset:4096
    ds_read_b64_tr_b16 v[36:37], v14 offset:4096
    ds_read_b64_tr_b16 v[38:39], v14 offset:4608
    s_waitcnt lgkmcnt(4)
    v_mfma_f32_32x32x16_bf16 v[64:79], v[48:51], v[40:43], v[64:79]
    v_mfma_f32_32x32x16_bf16 v[80:95], v[48:51], v[44:47], v[80:95]
    ds_read_b128 v[40:43], v13 offset:0
    ds_read_b128 v[44:47], v13 offset:4096
    ds_read_b64_tr_b16 v[48:49], v14 offset:6144
    ds_read_b64_tr_b16 v[50:51], v14 offset:6656
    s_waitcnt lgkmcnt(4)
    v_mfma_f32_32x32x16_bf16 v[64:79], v[36:39], v[28:31], v[64:79]
    v_mfma_f32_32x32x16_bf16 v[80:95], v[36:39], v[32:35], v[80:95]
    s_add_u32 s43, s43, 1
    s_cmp_ge_u32 s43, s27
    s_cbranch_scc1 KLAST_gemm2_kernel_3
    s_add_u32 s38, s43, 2
    s_cmp_eq_u32 s38, s31
    s_cbranch_scc1 W0_gemm2_kernel_5
    s_waitcnt vmcnt(0) lgkmcnt(0)
    s_branch W1_gemm2_kernel_6
W0_gemm2_kernel_5:
    s_waitcnt vmcnt(6) lgkmcnt(0)
W1_gemm2_kernel_6:
    s_barrier
    s_mov_b32 s35, s34
    s_add_u32 s34, s34, 24576
    s_cmp_eq_u32 s34, 73728
    s_cselect_b32 s34, 0, s34
    s_sub_u32 s38, s34, s35
    v_add_u32 v10, s38, v10
    v_add_u32 v11, s38, v11
    v_add_u32 v12, s38, v12
    v_add_u32 v13, s38, v13
    v_add_u32 v14, s38, v14
    ds_read_b128 v[28:31], v10 offset:0
    ds_read_b128 v[32:35], v10 offset:4096
    ds_read_b64_tr_b16 v[36:37], v14 offset:0
    ds_read_b64_tr_b16 v[38:39], v14 offset:512
    s_cmp_ge_u32 s31, s27
    s_cbranch_scc1 NODMA_gemm2_kernel_4
    s_lshr_b32 s38, s31, 2
    s_and_b32 s39, s38, 1
    s_lshr_b32 s38, s38, 1
    s_lshl_b32 s40, 2048, s38
    s_sub_u32 s38, 0, s40
    s_cmp_eq_u32 s39, 1
    s_cselect_b32 s40, s40, s38
    s_lshl_b32 s38, s28, 11
    s_add_u32 s40, s40, s38
    v_add_u32 v21, s40, v15
    v_add_u32 v22, s40, v16
    v_add_u32 v23, s40, v17
    v_add_u32 v24, s40, v18
    s_add_u32 m0, s35, s36
    s_nop 0
    buffer_load_dwordx4 v21, s[4:7], s32 offen lds
    s_add_u32 m0, m0, 1024
    s_nop 0
    buffer_load_dwordx4 v22, s[4:7], s32 offen lds
    s_add_u32 m0, m0, 1024
    s_nop 0
    buffer_load_dwordx4 v23, s[4:7], s32 offen lds
    s_add_u32 m0, m0, 1024
    s_nop 0
    buffer_load_dwordx4 v24, s[4:7], s32 offen lds
    s_add_u32 m0, s35, s37
    s_nop 0
    buffer_load_dwordx4 v19, s[8:11], s33 offen lds
    s_add_u32 m0, m0, 1024
    s_nop 0
    buffer_load_dwordx4 v20, s[8:11], s33 offen lds
    s_add_u32 s32, s32, 128
    s_add_u32 s33, s33, s42
    s_add_u32 s31, s31, 1
NODMA_gemm2_kernel_4:
    v_mfma_f32_32x32x16_bf16 v[64:79], v[48:51], v[40:43], v[64:79]
    v_mfma_f32_32x32x16_bf16 v[80:95], v[48:51], v[44:47], v[80:95]
    s_branch KLOOP_gemm2_kernel_2
KLAST_gemm2_kernel_3:
    s_waitcnt lgkmcnt(0)
    v_mfma_f32_32x32x16_bf16 v[64:79], v[48:51], v[40:43], v[64:79]
    v_mfma_f32_32x32x16_bf16 v[80:95], v[48:51], v[44:47], v[80:95]
KDONE_gemm2_kernel_7:
    s_sub_u32 s38, 0, s34
    v_add_u32 v10, s38, v10
    v_add_u32 v11, s38, v11
    v_add_u32 v12, s38, v12
    v_add_u32 v13, s38, v13
    v_add_u32 v14, s38, v14
    s_barrier
    v_and_b32 v1, 63, v0
    v_lshrrev_b32 v2, 3, v1
    s_mul_i32 s38, s30, 32
    v_add_u32 v2, s38, v2
    v_and_b32 v3, 7, v1
    v_and_b32 v4, 7, v2
    v_lshlrev_b32 v5, 1, v3
    v_xor_b32 v4, v4, v5
    v_mul_u32_u24 v5, 256, v2
    v_lshl_add_u32 v5, v4, 4, v5
    v_add_u32 v4, s28, v2
    v_mul_lo_u32 v6, v4, s26
    v_lshl_add_u32 v6, v3, 4, v6
    s_lshl_b32 s38, s29, 1
    v_add_u32 v6, s38, v6
    v_lshlrev_b32 v7, 2, v4
    s_mul_i32 s39, s26, 0
    buffer_load_dwordx4 v[124:127], v6, s[16:19], s39 offen
    s_mul_i32 s39, s26, 8
    buffer_load_dwordx4 v[128:131], v6, s[16:19], s39 offen
    s_mul_i32 s39, s26, 16
    buffer_load_dwordx4 v[132:135], v6, s[16:19], s39 offen
    s_mul_i32 s39, s26, 24
    buffer_load_dwordx4 v[136:139], v6, s[16:19], s39 offen
    s_nop 15
    s_nop 7
    s_and_b32 s42, s30, 1
    s_lshr_b32 s43, s30, 1
    v_and_b32 v1, 31, v0
    s_mul_i32 s38, s42, 64
    v_add_u32 v1, s38, v1
    v_mul_u32_u24 v2, 256, v1
    v_and_b32 v1, 7, v0
    v_bfe_u32 v3, v0, 5, 1
    v_xor_b32 v1, v1, v3
    s_mul_i32 s38, s43, 8
    v_xor_b32 v1, s38, v1
    v_lshl_add_u32 v2, v1, 4, v2
    v_xor_b32 v1, 0, v2
    ds_write_b128 v1, v[64:67] offset:0
    v_xor_b32 v1, 32, v2
    ds_write_b128 v1, v[68:71] offset:0
    v_xor_b32 v1, 64, v2
    ds_write_b128 v1, v[72:75] offset:0
    v_xor_b32 v1, 96, v2
    ds_write_b128 v1, v[76:79] offset:0
    v_xor_b32 v1, 0, v2
    ds_write_b128 v1, v[80:83] offset:8192
    v_xor_b32 v1, 32, v2
    ds_write_b128 v1, v[84:87] offset:8192
    v_xor_b32 v1, 64, v2
    ds_write_b128 v1, v[88:91] offset:8192
    v_xor_b32 v1, 96, v2
    ds_write_b128 v1, v[92:95] offset:8192
    s_waitcnt lgkmcnt(0)
    s_barrier
    s_mov_b32 s39, 0
    s_mul_i32 s43, s26, 8
    v_xor_b32 v1, 16, v5
    ds_read_b128 v[96:99], v5
    ds_read_b128 v[100:103], v1
    s_waitcnt vmcnt(0) lgkmcnt(0)
    v_cvt_pk_bf16_f32 v112, v96, v97
    v_lshlrev_b32 v96, 16, v112
    v_and_b32 v97, 0xffff0000, v112
    v_lshlrev_b32 v112, 16, v124
    v_and_b32 v113, 0xffff0000, v124
    v_pk_add_f32 v[96:97], v[96:97], v[112:113]
    v_cvt_pk_bf16_f32 v120, v96, v97
    v_cvt_pk_bf16_f32 v112, v98, v99
    v_lshlrev_b32 v98, 16, v112
    v_and_b32 v99, 0xffff0000, v112
    v_lshlrev_b32 v112, 16, v125
    v_and_b32 v113, 0xffff0000, v125
    v_pk_add_f32 v[98:99], v[98:99], v[112:113]
    v_cvt_pk_bf16_f32 v121, v98, v99
    v_cvt_pk_bf16_f32 v112, v100, v101
    v_lshlrev_b32 v100, 16, v112
    v_and_b32 v101, 0xffff0000, v112
    v_lshlrev_b32 v112, 16, v126
    v_and_b32 v113, 0xffff0000, v126
    v_pk_add_f32 v[100:101], v[100:101], v[112:113]
    v_cvt_pk_bf16_f32 v122, v100, v101
    v_cvt_pk_bf16_f32 v112, v102, v103
    v_lshlrev_b32 v102, 16, v112
    v_and_b32 v103, 0xffff0000, v112
    v_lshlrev_b32 v112, 16, v127
    v_and_b32 v113, 0xffff0000, v127
    v_pk_add_f32 v[102:103], v[102:103], v[112:113]
    v_cvt_pk_bf16_f32 v123, v102, v103
    buffer_store_dwordx4 v[120:123], v6, s[12:15], s39 offen
    v_add_u32 v5, 2048, v5
    s_add_u32 s39, s39, s43
    v_xor_b32 v1, 16, v5
    ds_read_b128 v[96:99], v5
    ds_read_b128 v[100:103], v1
    s_waitcnt lgkmcnt(0)
    v_cvt_pk_bf16_f32 v112, v96, v97
    v_lshlrev_b32 v96, 16, v112
    v_and_b32 v97, 0xffff0000, v112
    v_lshlrev_b32 v112, 16, v128
    v_and_b32 v113, 0xffff0000, v128
    v_pk_add_f32 v[96:97], v[96:97], v[112:113]
    v_cvt_pk_bf16_f32 v120, v96, v97
    v_cvt_pk_bf16_f32 v112, v98, v99
    v_lshlrev_b32 v98, 16, v112
    v_and_b32 v99, 0xffff0000, v112
    v_lshlrev_b32 v112, 16, v129
    v_and_b32 v113, 0xffff0000, v129
    v_pk_add_f32 v[98:99], v[98:99], v[112:113]
    v_cvt_pk_bf16_f32 v121, v98, v99
    v_cvt_pk_bf16_f32 v112, v100, v101
    v_lshlrev_b32 v100, 16, v112
    v_and_b32 v101, 0xffff0000, v112
    v_lshlrev_b32 v112, 16, v130
    v_and_b32 v113, 0xffff0000, v130
    v_pk_add_f32 v[100:101], v[100:101], v[112:113]
    v_cvt_pk_bf16_f32 v122, v100, v101
    v_cvt_pk_bf16_f32 v112, v102, v103
    v_lshlrev_b32 v102, 16, v112
    v_and_b32 v103, 0xffff0000, v112
    v_lshlrev_b32 v112, 16, v131
    v_and_b32 v113, 0xffff0000, v131
    v_pk_add_f32 v[102:103], v[102:103], v[112:113]
    v_cvt_pk_bf16_f32 v123, v102, v103
    buffer_store_dwordx4 v[120:123], v6, s[12:15], s39 offen
    v_add_u32 v5, 2048, v5
    s_add_u32 s39, s39, s43
    v_xor_b32 v1, 16, v5
    ds_read_b128 v[96:99], v5
    ds_read_b128 v[100:103], v1
    s_waitcnt lgkmcnt(0)
    v_cvt_pk_bf16_f32 v112, v96, v97
    v_lshlrev_b32 v96, 16, v112
    v_and_b32 v97, 0xffff0000, v112
    v_lshlrev_b32 v112, 16, v132
    v_and_b32 v113, 0xffff0000, v132
    v_pk_add_f32 v[96:97], v[96:97], v[112:113]
    v_cvt_pk_bf16_f32 v120, v96, v97
    v_cvt_pk_bf16_f32 v112, v98, v99
    v_lshlrev_b32 v98, 16, v112
    v_and_b32 v99, 0xffff0000, v112
    v_lshlrev_b32 v112, 16, v133
    v_and_b32 v113, 0xffff0000, v133
    v_pk_add_f32 v[98:99], v[98:99], v[112:113]
    v_cvt_pk_bf16_f32 v121, v98, v99
    v_cvt_pk_bf16_f32 v112, v100, v101
    v_lshlrev_b32 v100, 16, v112
    v_and_b32 v101, 0xffff0000, v112
    v_lshlrev_b32 v112, 16, v134
    v_and_b32 v113, 0xffff0000, v134
    v_pk_add_f32 v[100:101], v[100:101], v[112:113]
    v_cvt_pk_bf16_f32 v122, v100, v101
    v_cvt_pk_bf16_f32 v112, v102, v103
    v_lshlrev_b32 v102, 16, v112
    v_and_b32 v103, 0xffff0000, v112
    v_lshlrev_b32 v112, 16, v135
    v_and_b32 v113, 0xffff0000, v135
    v_pk_add_f32 v[102:103], v[102:103], v[112:113]
    v_cvt_pk_bf16_f32 v123, v102, v103
    buffer_store_dwordx4 v[120:123], v6, s[12:15], s39 offen
    v_add_u32 v5, 2048, v5
    s_add_u32 s39, s39, s43
    v_xor_b32 v1, 16, v5
    ds_read_b128 v[96:99], v5
    ds_read_b128 v[100:103], v1
    s_waitcnt lgkmcnt(0)
    v_cvt_pk_bf16_f32 v112, v96, v97
    v_lshlrev_b32 v96, 16, v112
    v_and_b32 v97, 0xffff0000, v112
    v_lshlrev_b32 v112, 16, v136
    v_and_b32 v113, 0xffff0000, v136
    v_pk_add_f32 v[96:97], v[96:97], v[112:113]
    v_cvt_pk_bf16_f32 v120, v96, v97
    v_cvt_pk_bf16_f32 v112, v98, v99
    v_lshlrev_b32 v98, 16, v112
    v_and_b32 v99, 0xffff0000, v112
    v_lshlrev_b32 v112, 16, v137
    v_and_b32 v113, 0xffff0000, v137
    v_pk_add_f32 v[98:99], v[98:99], v[112:113]
    v_cvt_pk_bf16_f32 v121, v98, v99
    v_cvt_pk_bf16_f32 v112, v100, v101
    v_lshlrev_b32 v100, 16, v112
    v_and_b32 v101, 0xffff0000, v112
    v_lshlrev_b32 v112, 16, v138
    v_and_b32 v113, 0xffff0000, v138
    v_pk_add_f32 v[100:101], v[100:101], v[112:113]
    v_cvt_pk_bf16_f32 v122, v100, v101
    v_cvt_pk_bf16_f32 v112, v102, v103
    v_lshlrev_b32 v102, 16, v112
    v_and_b32 v103, 0xffff0000, v112
    v_lshlrev_b32 v112, 16, v139
    v_and_b32 v113, 0xffff0000, v139
    v_pk_add_f32 v[102:103], v[102:103], v[112:113]
    v_cvt_pk_bf16_f32 v123, v102, v103
    buffer_store_dwordx4 v[120:123], v6, s[12:15], s39 offen
    v_add_u32 v5, 2048, v5
    s_add_u32 s39, s39, s43
END_gemm2_kernel_1:
    s_endpgm
BODY2_g2kv_kernel_1:
    s_sub_u32 s2, s2, 256
    s_cmp_ge_u32 s2, 256
    s_cbranch_scc1 END_kv_kernel_1
    s_load_dwordx2 s[4:5], s[0:1], 96
    s_load_dwordx2 s[6:7], s[0:1], 16
    v_lshrrev_b32 v1, 6, v0
    s_nop 0
    v_readfirstlane_b32 s12, v1
    s_waitcnt lgkmcnt(0)
    s_add_u32 s16, s4, 0x400000
    s_addc_u32 s17, s5, 0
    s_mov_b32 s18, 0xc00000
    s_mov_b32 s19, 0x00020000
    s_add_u32 s20, s6, 0x0
    s_addc_u32 s21, s7, 0
    s_mov_b32 s22, 0x10000
    s_mov_b32 s23, 0x00020000
    s_add_u32 s24, s4, 0x3000000
    s_addc_u32 s25, s5, 0
    s_mov_b32 s26, 0x210000
    s_mov_b32 s27, 0x00020000
    s_and_b32 s13, s2, 31
    s_lshr_b32 s14, s2, 5
    v_and_b32 v1, 63, v0
    v_and_b32 v2, 31, v0
    v_bfe_u32 v3, v0, 5, 1
    v_xor_b32 v4, 32, v1
    v_lshlrev_b32 v4, 2, v4
    v_lshlrev_b32 v5, 9, v3
    v_lshl_add_u32 v5, v2, 1, v5
    s_lshl_b32 s40, s13, 11
    buffer_load_ushort v144, v5, s[20:23], s40 offen offset:0
    buffer_load_ushort v145, v5, s[20:23], s40 offen offset:64
    buffer_load_ushort v146, v5, s[20:23], s40 offen offset:128
    buffer_load_ushort v147, v5, s[20:23], s40 offen offset:192
    buffer_load_ushort v148, v5, s[20:23], s40 offen offset:256
    buffer_load_ushort v149, v5, s[20:23], s40 offen offset:320
    buffer_load_ushort v150, v5, s[20:23], s40 offen offset:384
    buffer_load_ushort v151, v5, s[20:23], s40 offen offset:448
    buffer_load_ushort v152, v5, s[20:23], s40 offen offset:1024
    buffer_load_ushort v153, v5, s[20:23], s40 offen offset:1088
    buffer_load_ushort v154, v5, s[20:23], s40 offen offset:1152
    buffer_load_ushort v155, v5, s[20:23], s40 offen offset:1216
    buffer_load_ushort v156, v5, s[20:23], s40 offen offset:1280
    buffer_load_ushort v157, v5, s[20:23], s40 offen offset:1344
    buffer_load_ushort v158, v5, s[20:23], s40 offen offset:1408
    buffer_load_ushort v159, v5, s[20:23], s40 offen offset:1472
    s_waitcnt vmcnt(0)
    v_lshl_or_b32 v8, v145, 16, v144
    v_lshl_or_b32 v9, v147, 16, v146
    v_lshl_or_b32 v10, v149, 16, v148
    v_lshl_or_b32 v11, v151, 16, v150
    v_lshl_or_b32 v12, v153, 16, v152
    v_lshl_or_b32 v13, v155, 16, v154
    v_lshl_or_b32 v14, v157, 16, v156
    v_lshl_or_b32 v15, v159, 16, v158
    s_mul_i32 s15, s12, 6144
    v_lshlrev_b32 v5, 8, v3
    v_lshl_add_u32 v5, v2, 1, v5
    v_add_u32 v5, s15, v5
    v_lshlrev_b32 v6, 6, v2
    v_lshl_add_u32 v6, v3, 4, v6
    v_add_u32 v6, s15, v6
    v_bfe_u32 v7, v0, 2, 2
    v_lshl_add_u32 v7, v3, 3, v7
    v_lshlrev_b32 v7, 6, v7
    v_bfe_u32 v16, v0, 4, 1
    v_lshl_add_u32 v7, v16, 5, v7
    v_and_b32 v16, 3, v0
    v_lshl_add_u32 v7, v16, 3, v7
    v_add_u32 v7, s15, v7
    v_add_u32 v7, 4096, v7
    v_lshlrev_b32 v17, 4, v1
    v_add_u32 v17, s15, v17
    v_mov_b32 v20, 0x3f803f80
    v_mov_b32 v21, 0x3f803f80
    v_mov_b32 v22, 0x3f803f80
    v_mov_b32 v23, 0x3f803f80
    v_mov_b32 v64, 0
    v_mov_b32 v65, 0
    v_mov_b32 v66, 0
    v_mov_b32 v67, 0
    v_mov_b32 v68, 0
    v_mov_b32 v69, 0
    v_mov_b32 v70, 0
    v_mov_b32 v71, 0
    v_mov_b32 v72, 0
    v_mov_b32 v73, 0
    v_mov_b32 v74, 0
    v_mov_b32 v75, 0
    v_mov_b32 v76, 0
    v_mov_b32 v77, 0
    v_mov_b32 v78, 0
    v_mov_b32 v79, 0
    v_mov_b32 v80, 0
    v_mov_b32 v81, 0
    v_mov_b32 v82, 0
    v_mov_b32 v83, 0
    v_mov_b32 v84, 0
    v_mov_b32 v85, 0
    v_mov_b32 v86, 0
    v_mov_b32 v87, 0
    v_mov_b32 v88, 0
    v_mov_b32 v89, 0
    v_mov_b32 v90, 0
    v_mov_b32 v91, 0
    v_mov_b32 v92, 0
    v_mov_b32 v93, 0
    v_mov_b32 v94, 0
    v_mov_b32 v95, 0
    v_mov_b32 v96, 0
    v_mov_b32 v97, 0
    v_mov_b32 v98, 0
    v_mov_b32 v99, 0
    v_mov_b32 v100, 0
    v_mov_b32 v101, 0
    v_mov_b32 v102, 0
    v_mov_b32 v103, 0
    v_mov_b32 v104, 0
    v_mov_b32 v105, 0
    v_mov_b32 v106, 0
    v_mov_b32 v107, 0
    v_mov_b32 v108, 0
    v_mov_b32 v109, 0
    v_mov_b32 v110, 0
    v_mov_b32 v111, 0
    v_mov_b32 v112, 0
    v_mov_b32 v113, 0
    v_mov_b32 v114, 0
    v_mov_b32 v115, 0
    v_mov_b32 v116, 0
    v_mov_b32 v117, 0
    v_mov_b32 v118, 0
    v_mov_b32 v119, 0
    v_mov_b32 v120, 0
    v_mov_b32 v121, 0
    v_mov_b32 v122, 0
    v_mov_b32 v123, 0
    v_mov_b32 v124, 0
    v_mov_b32 v125, 0
    v_mov_b32 v126, 0
    v_mov_b32 v127, 0
    s_lshl_b32 s30, s14, 8
    s_lshl_b32 s31, s12, 6
    s_add_u32 s30, s30, s31
    s_add_u32 s30, s30, 0
    s_mul_i32 s31, s30, 6144
    s_lshl_b32 s32, s13, 6
    s_add_u32 s31, s31, s32
    v_mul_u32_u24 v18, 6144, v2
    v_lshl_add_u32 v18, v3, 4, v18
    s_add_u32 s33, s31, 2048
    buffer_load_dwordx4 v[24:27], v18, s[16:19], s33 offen
    buffer_load_dwordx4 v[28:31], v18, s[16:19], s33 offen offset:32
    v_lshrrev_b32 v19, 2, v1
    v_mul_u32_u24 v19, 6144, v19
    v_and_b32 v16, 3, v1
    v_lshl_add_u32 v19, v16, 4, v19
    s_add_u32 s33, s31, 4096
    buffer_load_dwordx4 v[32:35], v19, s[16:19], s33 offen
    s_add_u32 s33, s33, 98304
    buffer_load_dwordx4 v[36:39], v19, s[16:19], s33 offen
    v_mov_b32 v128, 0
    v_mov_b32 v129, 0
    v_mov_b32 v130, 0
    v_mov_b32 v131, 0
    v_mov_b32 v132, 0
    v_mov_b32 v133, 0
    v_mov_b32 v134, 0
    v_mov_b32 v135, 0
    v_mov_b32 v136, 0
    v_mov_b32 v137, 0
    v_mov_b32 v138, 0
    v_mov_b32 v139, 0
    v_mov_b32 v140, 0
    v_mov_b32 v141, 0
    v_mov_b32 v142, 0
    v_mov_b32 v143, 0
    s_waitcnt vmcnt(0)
    ds_write_b128 v17, v[32:35] offset:4096
    ds_write_b128 v17, v[36:39] offset:5120
    v_mfma_f32_32x32x16_bf16 v[128:143], v[8:11], v[24:27], v[128:143]
    v_mfma_f32_32x32x16_bf16 v[128:143], v[12:15], v[28:31], v[128:143]
    s_nop 15
    s_nop 3
    v_cvt_pk_bf16_f32 v146, v128, v129
    v_lshlrev_b32 v128, 16, v146
    v_and_b32 v129, 0xffff0000, v146
    v_cvt_pk_bf16_f32 v146, v130, v131
    v_lshlrev_b32 v130, 16, v146
    v_and_b32 v131, 0xffff0000, v146
    v_cvt_pk_bf16_f32 v146, v132, v133
    v_lshlrev_b32 v132, 16, v146
    v_and_b32 v133, 0xffff0000, v146
    v_cvt_pk_bf16_f32 v146, v134, v135
    v_lshlrev_b32 v134, 16, v146
    v_and_b32 v135, 0xffff0000, v146
    v_cvt_pk_bf16_f32 v146, v136, v137
    v_lshlrev_b32 v136, 16, v146
    v_and_b32 v137, 0xffff0000, v146
    v_cvt_pk_bf16_f32 v146, v138, v139
    v_lshlrev_b32 v138, 16, v146
    v_and_b32 v139, 0xffff0000, v146
    v_cvt_pk_bf16_f32 v146, v140, v141
    v_lshlrev_b32 v140, 16, v146
    v_and_b32 v141, 0xffff0000, v146
    v_cvt_pk_bf16_f32 v146, v142, v143
    v_lshlrev_b32 v142, 16, v146
    v_and_b32 v143, 0xffff0000, v146
    v_max_f32 v144, v128, v129
    v_min_f32 v145, v128, v129
    v_max3_f32 v144, v144, v130, v131
    v_min3_f32 v145, v145, v130, v131
    v_max3_f32 v144, v144, v132, v133
    v_min3_f32 v145, v145, v132, v133
    v_max3_f32 v144, v144, v134, v135
    v_min3_f32 v145, v145, v134, v135
    v_max3_f32 v144, v144, v136, v137
    v_min3_f32 v145, v145, v136, v137
    v_max3_f32 v144, v144, v138, v139
    v_min3_f32 v145, v145, v138, v139
    v_max3_f32 v144, v144, v140, v141
    v_min3_f32 v145, v145, v140, v141
    v_max3_f32 v144, v144, v142, v143
    v_min3_f32 v145, v145, v142, v143
    ds_bpermute_b32 v146, v4, v144
    ds_bpermute_b32 v147, v4, v145
    s_waitcnt lgkmcnt(0)
    v_max_f32 v144, v144, v146
    v_min_f32 v145, v145, v147
    v_mul_f32 v144, 0xbfb8aa3b, v144
    v_mul_f32 v145, 0x3fb8aa3b, v145
    v_mov_b32 v146, 0x3fb8aa3b
    v_fma_f32 v150, v128, v146, v144
    v_fma_f32 v166, -v128, v146, v145
    v_exp_f32 v150, v150
    v_exp_f32 v166, v166
    v_fma_f32 v151, v129, v146, v144
    v_fma_f32 v167, -v129, v146, v145
    v_exp_f32 v151, v151
    v_exp_f32 v167, v167
    v_fma_f32 v152, v130, v146, v144
    v_fma_f32 v168, -v130, v146, v145
    v_exp_f32 v152, v152
    v_exp_f32 v168, v168
    v_fma_f32 v153, v131, v146, v144
    v_fma_f32 v169, -v131, v146, v145
    v_exp_f32 v153, v153
    v_exp_f32 v169, v169
    v_fma_f32 v154, v132, v146, v144
    v_fma_f32 v170, -v132, v146, v145
    v_exp_f32 v154, v154
    v_exp_f32 v170, v170
    v_fma_f32 v155, v133, v146, v144
    v_fma_f32 v171, -v133, v146, v145
    v_exp_f32 v155, v155
    v_exp_f32 v171, v171
    v_fma_f32 v156, v134, v146, v144
    v_fma_f32 v172, -v134, v146, v145
    v_exp_f32 v156, v156
    v_exp_f32 v172, v172
    v_fma_f32 v157, v135, v146, v144
    v_fma_f32 v173, -v135, v146, v145
    v_exp_f32 v157, v157
    v_exp_f32 v173, v173
    v_fma_f32 v158, v136, v146, v144
    v_fma_f32 v174, -v136, v146, v145
    v_exp_f32 v158, v158
    v_exp_f32 v174, v174
    v_fma_f32 v159, v137, v146, v144
    v_fma_f32 v175, -v137, v146, v145
    v_exp_f32 v159, v159
    v_exp_f32 v175, v175
    v_fma_f32 v160, v138, v146, v144
    v_fma_f32 v176, -v138, v146, v145
    v_exp_f32 v160, v160
    v_exp_f32 v176, v176
    v_fma_f32 v161, v139, v146, v144
    v_fma_f32 v177, -v139, v146, v145
    v_exp_f32 v161, v161
    v_exp_f32 v177, v177
    v_fma_f32 v162, v140, v146, v144
    v_fma_f32 v178, -v140, v146, v145
    v_exp_f32 v162, v162
    v_exp_f32 v178, v178
    v_fma_f32 v163, v141, v146, v144
    v_fma_f32 v179, -v141, v146, v145
    v_exp_f32 v163, v163
    v_exp_f32 v179, v179
    v_fma_f32 v164, v142, v146, v144
    v_fma_f32 v180, -v142, v146, v145
    v_exp_f32 v164, v164
    v_exp_f32 v180, v180
    v_fma_f32 v165, v143, v146, v144
    v_fma_f32 v181, -v143, v146, v145
    v_exp_f32 v165, v165
    v_exp_f32 v181, v181
    s_nop 0
    v_add_f32 v148, v150, v151
    v_add_f32 v149, v166, v167
    v_add_f32 v148, v148, v152
    v_add_f32 v149, v149, v168
    v_add_f32 v148, v148, v153
    v_add_f32 v149, v149, v169
    v_add_f32 v148, v148, v154
    v_add_f32 v149, v149, v170
    v_add_f32 v148, v148, v155
    v_add_f32 v149, v149, v171
    v_add_f32 v148, v148, v156
    v_add_f32 v149, v149, v172
    v_add_f32 v148, v148, v157
    v_add_f32 v149, v149, v173
    v_add_f32 v148, v148, v158
    v_add_f32 v149, v149, v174
    v_add_f32 v148, v148, v159
    v_add_f32 v149, v149, v175
    v_add_f32 v148, v148, v160
    v_add_f32 v149, v149, v176
    v_add_f32 v148, v148, v161
    v_add_f32 v149, v149, v177
    v_add_f32 v148, v148, v162
    v_add_f32 v149, v149, v178
    v_add_f32 v148, v148, v163
    v_add_f32 v149, v149, v179
    v_add_f32 v148, v148, v164
    v_add_f32 v149, v149, v180
    v_add_f32 v148, v148, v165
    v_add_f32 v149, v149, v181
    ds_bpermute_b32 v146, v4, v148
    ds_bpermute_b32 v147, v4, v149
    s_waitcnt lgkmcnt(0)
    v_add_f32 v148, v148, v146
    v_add_f32 v149, v149, v147
    v_rcp_f32 v148, v148
    v_rcp_f32 v149, v149
    s_nop 0
    v_mul_f32 v150, v150, v148
    v_mul_f32 v151, v151, v148
    v_cvt_pk_bf16_f32 v40, v150, v151
    v_mul_f32 v166, v166, v149
    v_mul_f32 v167, v167, v149
    v_cvt_pk_bf16_f32 v48, v166, v167
    v_mul_f32 v152, v152, v148
    v_mul_f32 v153, v153, v148
    v_cvt_pk_bf16_f32 v41, v152, v153
    v_mul_f32 v168, v168, v149
    v_mul_f32 v169, v169, v149
    v_cvt_pk_bf16_f32 v49, v168, v169
    v_mul_f32 v154, v154, v148
    v_mul_f32 v155, v155, v148
    v_cvt_pk_bf16_f32 v42, v154, v155
    v_mul_f32 v170, v170, v149
    v_mul_f32 v171, v171, v149
    v_cvt_pk_bf16_f32 v50, v170, v171
    v_mul_f32 v156, v156, v148
    v_mul_f32 v157, v157, v148
    v_cvt_pk_bf16_f32 v43, v156, v157
    v_mul_f32 v172, v172, v149
    v_mul_f32 v173, v173, v149
    v_cvt_pk_bf16_f32 v51, v172, v173
    v_mul_f32 v158, v158, v148
    v_mul_f32 v159, v159, v148
    v_cvt_pk_bf16_f32 v44, v158, v159
    v_mul_f32 v174, v174, v149
    v_mul_f32 v175, v175, v149
    v_cvt_pk_bf16_f32 v52, v174, v175
    v_mul_f32 v160, v160, v148
    v_mul_f32 v161, v161, v148
    v_cvt_pk_bf16_f32 v45, v160, v161
    v_mul_f32 v176, v176, v149
    v_mul_f32 v177, v177, v149
    v_cvt_pk_bf16_f32 v53, v176, v177
    v_mul_f32 v162, v162, v148
    v_mul_f32 v163, v163, v148
    v_cvt_pk_bf16_f32 v46, v162, v163
    v_mul_f32 v178, v178, v149
    v_mul_f32 v179, v179, v149
    v_cvt_pk_bf16_f32 v54, v178, v179
    v_mul_f32 v164, v164, v148
    v_mul_f32 v165, v165, v148
    v_cvt_pk_bf16_f32 v47, v164, v165
    v_mul_f32 v180, v180, v149
    v_mul_f32 v181, v181, v149
    v_cvt_pk_bf16_f32 v55, v180, v181
    ds_write_b16 v5, v40 offset:0
    ds_write_b16_d16_hi v5, v40 offset:64
    ds_write_b16 v5, v41 offset:128
    ds_write_b16_d16_hi v5, v41 offset:192
    ds_write_b16 v5, v42 offset:512
    ds_write_b16_d16_hi v5, v42 offset:576
    ds_write_b16 v5, v43 offset:640
    ds_write_b16_d16_hi v5, v43 offset:704
    ds_write_b16 v5, v44 offset:1024
    ds_write_b16_d16_hi v5, v44 offset:1088
    ds_write_b16 v5, v45 offset:1152
    ds_write_b16_d16_hi v5, v45 offset:1216
    ds_write_b16 v5, v46 offset:1536
    ds_write_b16_d16_hi v5, v46 offset:1600
    ds_write_b16 v5, v47 offset:1664
    ds_write_b16_d16_hi v5, v47 offset:1728
    ds_write_b16 v5, v48 offset:2048
    ds_write_b16_d16_hi v5, v48 offset:2112
    ds_write_b16 v5, v49 offset:2176
    ds_write_b16_d16_hi v5, v49 offset:2240
    ds_write_b16 v5, v50 offset:2560
    ds_write_b16_d16_hi v5, v50 offset:2624
    ds_write_b16 v5, v51 offset:2688
    ds_write_b16_d16_hi v5, v51 offset:2752
    ds_write_b16 v5, v52 offset:3072
    ds_write_b16_d16_hi v5, v52 offset:3136
    ds_write_b16 v5, v53 offset:3200
    ds_write_b16_d16_hi v5, v53 offset:3264
    ds_write_b16 v5, v54 offset:3584
    ds_write_b16_d16_hi v5, v54 offset:3648
    ds_write_b16 v5, v55 offset:3712
    ds_write_b16_d16_hi v5, v55 offset:3776
    s_waitcnt lgkmcnt(0)
    ds_read_b64_tr_b16 v[60:61], v7 offset:0
    ds_read_b64_tr_b16 v[62:63], v7 offset:256
    ds_read_b128 v[56:59], v6 offset:0
    s_waitcnt lgkmcnt(0)
    v_mfma_f32_32x32x16_bf16 v[64:79], v[56:59], v[60:63], v[64:79]
    v_mfma_f32_32x32x16_bf16 v[96:111], v[56:59], v[20:23], v[96:111]
    s_nop 7
    ds_read_b128 v[56:59], v6 offset:2048
    s_waitcnt lgkmcnt(0)
    v_mfma_f32_32x32x16_bf16 v[80:95], v[56:59], v[60:63], v[80:95]
    v_mfma_f32_32x32x16_bf16 v[112:127], v[56:59], v[20:23], v[112:127]
    s_nop 7
    ds_read_b64_tr_b16 v[60:61], v7 offset:1024
    ds_read_b64_tr_b16 v[62:63], v7 offset:1280
    ds_read_b128 v[56:59], v6 offset:32
    s_waitcnt lgkmcnt(0)
    v_mfma_f32_32x32x16_bf16 v[64:79], v[56:59], v[60:63], v[64:79]
    v_mfma_f32_32x32x16_bf16 v[96:111], v[56:59], v[20:23], v[96:111]
    s_nop 7
    ds_read_b128 v[56:59], v6 offset:2080
    s_waitcnt lgkmcnt(0)
    v_mfma_f32_32x32x16_bf16 v[80:95], v[56:59], v[60:63], v[80:95]
    v_mfma_f32_32x32x16_bf16 v[112:127], v[56:59], v[20:23], v[112:127]
    s_nop 7
    s_nop 7
    s_lshl_b32 s30, s14, 8
    s_lshl_b32 s31, s12, 6
    s_add_u32 s30, s30, s31
    s_add_u32 s30, s30, 32
    s_mul_i32 s31, s30, 6144
    s_lshl_b32 s32, s13, 6
    s_add_u32 s31, s31, s32
    v_mul_u32_u24 v18, 6144, v2
    v_lshl_add_u32 v18, v3, 4, v18
    s_add_u32 s33, s31, 2048
    buffer_load_dwordx4 v[24:27], v18, s[16:19], s33 offen
    buffer_load_dwordx4 v[28:31], v18, s[16:19], s33 offen offset:32
    v_lshrrev_b32 v19, 2, v1
    v_mul_u32_u24 v19, 6144, v19
    v_and_b32 v16, 3, v1
    v_lshl_add_u32 v19, v16, 4, v19
    s_add_u32 s33, s31, 4096
    buffer_load_dwordx4 v[32:35], v19, s[16:19], s33 offen
    s_add_u32 s33, s33, 98304
    buffer_load_dwordx4 v[36:39], v19, s[16:19], s33 offen
    v_mov_b32 v128, 0
    v_mov_b32 v129, 0
    v_mov_b32 v130, 0
    v_mov_b32 v131, 0
    v_mov_b32 v132, 0
    v_mov_b32 v133, 0
    v_mov_b32 v134, 0
    v_mov_b32 v135, 0
    v_mov_b32 v136, 0
    v_mov_b32 v137, 0
    v_mov_b32 v138, 0
    v_mov_b32 v139, 0
    v_mov_b32 v140, 0
    v_mov_b32 v141, 0
    v_mov_b32 v142, 0
    v_mov_b32 v143, 0
    s_waitcnt vmcnt(0)
    ds_write_b128 v17, v[32:35] offset:4096
    ds_write_b128 v17, v[36:39] offset:5120
    v_mfma_f32_32x32x16_bf16 v[128:143], v[8:11], v[24:27], v[128:143]
    v_mfma_f32_32x32x16_bf16 v[128:143], v[12:15], v[28:31], v[128:143]
    s_nop 15
    s_nop 3
    v_cvt_pk_bf16_f32 v146, v128, v129
    v_lshlrev_b32 v128, 16, v146
    v_and_b32 v129, 0xffff0000, v146
    v_cvt_pk_bf16_f32 v146, v130, v131
    v_lshlrev_b32 v130, 16, v146
    v_and_b32 v131, 0xffff0000, v146
    v_cvt_pk_bf16_f32 v146, v132, v133
    v_lshlrev_b32 v132, 16, v146
    v_and_b32 v133, 0xffff0000, v146
    v_cvt_pk_bf16_f32 v146, v134, v135
    v_lshlrev_b32 v134, 16, v146
    v_and_b32 v135, 0xffff0000, v146
    v_cvt_pk_bf16_f32 v146, v136, v137
    v_lshlrev_b32 v136, 16, v146
    v_and_b32 v137, 0xffff0000, v146
    v_cvt_pk_bf16_f32 v146, v138, v139
    v_lshlrev_b32 v138, 16, v146
    v_and_b32 v139, 0xffff0000, v146
    v_cvt_pk_bf16_f32 v146, v140, v141
    v_lshlrev_b32 v140, 16, v146
    v_and_b32 v141, 0xffff0000, v146
    v_cvt_pk_bf16_f32 v146, v142, v143
    v_lshlrev_b32 v142, 16, v146
    v_and_b32 v143, 0xffff0000, v146
    v_max_f32 v144, v128, v129
    v_min_f32 v145, v128, v129
    v_max3_f32 v144, v144, v130, v131
    v_min3_f32 v145, v145, v130, v131
    v_max3_f32 v144, v144, v132, v133
    v_min3_f32 v145, v145, v132, v133
    v_max3_f32 v144, v144, v134, v135
    v_min3_f32 v145, v145, v134, v135
    v_max3_f32 v144, v144, v136, v137
    v_min3_f32 v145, v145, v136, v137
    v_max3_f32 v144, v144, v138, v139
    v_min3_f32 v145, v145, v138, v139
    v_max3_f32 v144, v144, v140, v141
    v_min3_f32 v145, v145, v140, v141
    v_max3_f32 v144, v144, v142, v143
    v_min3_f32 v145, v145, v142, v143
    ds_bpermute_b32 v146, v4, v144
    ds_bpermute_b32 v147, v4, v145
    s_waitcnt lgkmcnt(0)
    v_max_f32 v144, v144, v146
    v_min_f32 v145, v145, v147
    v_mul_f32 v144, 0xbfb8aa3b, v144
    v_mul_f32 v145, 0x3fb8aa3b, v145
    v_mov_b32 v146, 0x3fb8aa3b
    v_fma_f32 v150, v128, v146, v144
    v_fma_f32 v166, -v128, v146, v145
    v_exp_f32 v150, v150
    v_exp_f32 v166, v166
    v_fma_f32 v151, v129, v146, v144
    v_fma_f32 v167, -v129, v146, v145
    v_exp_f32 v151, v151
    v_exp_f32 v167, v167
    v_fma_f32 v152, v130, v146, v144
    v_fma_f32 v168, -v130, v146, v145
    v_exp_f32 v152, v152
    v_exp_f32 v168, v168
    v_fma_f32 v153, v131, v146, v144
    v_fma_f32 v169, -v131, v146, v145
    v_exp_f32 v153, v153
    v_exp_f32 v169, v169
    v_fma_f32 v154, v132, v146, v144
    v_fma_f32 v170, -v132, v146, v145
    v_exp_f32 v154, v154
    v_exp_f32 v170, v170
    v_fma_f32 v155, v133, v146, v144
    v_fma_f32 v171, -v133, v146, v145
    v_exp_f32 v155, v155
    v_exp_f32 v171, v171
    v_fma_f32 v156, v134, v146, v144
    v_fma_f32 v172, -v134, v146, v145
    v_exp_f32 v156, v156
    v_exp_f32 v172, v172
    v_fma_f32 v157, v135, v146, v144
    v_fma_f32 v173, -v135, v146, v145
    v_exp_f32 v157, v157
    v_exp_f32 v173, v173
    v_fma_f32 v158, v136, v146, v144
    v_fma_f32 v174, -v136, v146, v145
    v_exp_f32 v158, v158
    v_exp_f32 v174, v174
    v_fma_f32 v159, v137, v146, v144
    v_fma_f32 v175, -v137, v146, v145
    v_exp_f32 v159, v159
    v_exp_f32 v175, v175
    v_fma_f32 v160, v138, v146, v144
    v_fma_f32 v176, -v138, v146, v145
    v_exp_f32 v160, v160
    v_exp_f32 v176, v176
    v_fma_f32 v161, v139, v146, v144
    v_fma_f32 v177, -v139, v146, v145
    v_exp_f32 v161, v161
    v_exp_f32 v177, v177
    v_fma_f32 v162, v140, v146, v144
    v_fma_f32 v178, -v140, v146, v145
    v_exp_f32 v162, v162
    v_exp_f32 v178, v178
    v_fma_f32 v163, v141, v146, v144
    v_fma_f32 v179, -v141, v146, v145
    v_exp_f32 v163, v163
    v_exp_f32 v179, v179
    v_fma_f32 v164, v142, v146, v144
    v_fma_f32 v180, -v142, v146, v145
    v_exp_f32 v164, v164
    v_exp_f32 v180, v180
    v_fma_f32 v165, v143, v146, v144
    v_fma_f32 v181, -v143, v146, v145
    v_exp_f32 v165, v165
    v_exp_f32 v181, v181
    s_nop 0
    v_add_f32 v148, v150, v151
    v_add_f32 v149, v166, v167
    v_add_f32 v148, v148, v152
    v_add_f32 v149, v149, v168
    v_add_f32 v148, v148, v153
    v_add_f32 v149, v149, v169
    v_add_f32 v148, v148, v154
    v_add_f32 v149, v149, v170
    v_add_f32 v148, v148, v155
    v_add_f32 v149, v149, v171
    v_add_f32 v148, v148, v156
    v_add_f32 v149, v149, v172
    v_add_f32 v148, v148, v157
    v_add_f32 v149, v149, v173
    v_add_f32 v148, v148, v158
    v_add_f32 v149, v149, v174
    v_add_f32 v148, v148, v159
    v_add_f32 v149, v149, v175
    v_add_f32 v148, v148, v160
    v_add_f32 v149, v149, v176
    v_add_f32 v148, v148, v161
    v_add_f32 v149, v149, v177
    v_add_f32 v148, v148, v162
    v_add_f32 v149, v149, v178
    v_add_f32 v148, v148, v163
    v_add_f32 v149, v149, v179
    v_add_f32 v148, v148, v164
    v_add_f32 v149, v149, v180
    v_add_f32 v148, v148, v165
    v_add_f32 v149, v149, v181
    ds_bpermute_b32 v146, v4, v148
    ds_bpermute_b32 v147, v4, v149
    s_waitcnt lgkmcnt(0)
    v_add_f32 v148, v148, v146
    v_add_f32 v149, v149, v147
    v_rcp_f32 v148, v148
    v_rcp_f32 v149, v149
    s_nop 0
    v_mul_f32 v150, v150, v148
    v_mul_f32 v151, v151, v148
    v_cvt_pk_bf16_f32 v40, v150, v151
    v_mul_f32 v166, v166, v149
    v_mul_f32 v167, v167, v149
    v_cvt_pk_bf16_f32 v48, v166, v167
    v_mul_f32 v152, v152, v148
    v_mul_f32 v153, v153, v148
    v_cvt_pk_bf16_f32 v41, v152, v153
    v_mul_f32 v168, v168, v149
    v_mul_f32 v169, v169, v149
    v_cvt_pk_bf16_f32 v49, v168, v169
    v_mul_f32 v154, v154, v148
    v_mul_f32 v155, v155, v148
    v_cvt_pk_bf16_f32 v42, v154, v155
    v_mul_f32 v170, v170, v149
    v_mul_f32 v171, v171, v149
    v_cvt_pk_bf16_f32 v50, v170, v171
    v_mul_f32 v156, v156, v148
    v_mul_f32 v157, v157, v148
    v_cvt_pk_bf16_f32 v43, v156, v157
    v_mul_f32 v172, v172, v149
    v_mul_f32 v173, v173, v149
    v_cvt_pk_bf16_f32 v51, v172, v173
    v_mul_f32 v158, v158, v148
    v_mul_f32 v159, v159, v148
    v_cvt_pk_bf16_f32 v44, v158, v159
    v_mul_f32 v174, v174, v149
    v_mul_f32 v175, v175, v149
    v_cvt_pk_bf16_f32 v52, v174, v175
    v_mul_f32 v160, v160, v148
    v_mul_f32 v161, v161, v148
    v_cvt_pk_bf16_f32 v45, v160, v161
    v_mul_f32 v176, v176, v149
    v_mul_f32 v177, v177, v149
    v_cvt_pk_bf16_f32 v53, v176, v177
    v_mul_f32 v162, v162, v148
    v_mul_f32 v163, v163, v148
    v_cvt_pk_bf16_f32 v46, v162, v163
    v_mul_f32 v178, v178, v149
    v_mul_f32 v179, v179, v149
    v_cvt_pk_bf16_f32 v54, v178, v179
    v_mul_f32 v164, v164, v148
    v_mul_f32 v165, v165, v148
    v_cvt_pk_bf16_f32 v47, v164, v165
    v_mul_f32 v180, v180, v149
    v_mul_f32 v181, v181, v149
    v_cvt_pk_bf16_f32 v55, v180, v181
    ds_write_b16 v5, v40 offset:0
    ds_write_b16_d16_hi v5, v40 offset:64
    ds_write_b16 v5, v41 offset:128
    ds_write_b16_d16_hi v5, v41 offset:192
    ds_write_b16 v5, v42 offset:512
    ds_write_b16_d16_hi v5, v42 offset:576
    ds_write_b16 v5, v43 offset:640
    ds_write_b16_d16_hi v5, v43 offset:704
    ds_write_b16 v5, v44 offset:1024
    ds_write_b16_d16_hi v5, v44 offset:1088
    ds_write_b16 v5, v45 offset:1152
    ds_write_b16_d16_hi v5, v45 offset:1216
    ds_write_b16 v5, v46 offset:1536
    ds_write_b16_d16_hi v5, v46 offset:1600
    ds_write_b16 v5, v47 offset:1664
    ds_write_b16_d16_hi v5, v47 offset:1728
    ds_write_b16 v5, v48 offset:2048
    ds_write_b16_d16_hi v5, v48 offset:2112
    ds_write_b16 v5, v49 offset:2176
    ds_write_b16_d16_hi v5, v49 offset:2240
    ds_write_b16 v5, v50 offset:2560
    ds_write_b16_d16_hi v5, v50 offset:2624
    ds_write_b16 v5, v51 offset:2688
    ds_write_b16_d16_hi v5, v51 offset:2752
    ds_write_b16 v5, v52 offset:3072
    ds_write_b16_d16_hi v5, v52 offset:3136
    ds_write_b16 v5, v53 offset:3200
    ds_write_b16_d16_hi v5, v53 offset:3264
    ds_write_b16 v5, v54 offset:3584
    ds_write_b16_d16_hi v5, v54 offset:3648
    ds_write_b16 v5, v55 offset:3712
    ds_write_b16_d16_hi v5, v55 offset:3776
    s_waitcnt lgkmcnt(0)
    ds_read_b64_tr_b16 v[60:61], v7 offset:0
    ds_read_b64_tr_b16 v[62:63], v7 offset:256
    ds_read_b128 v[56:59], v6 offset:0
    s_waitcnt lgkmcnt(0)
    v_mfma_f32_32x32x16_bf16 v[64:79], v[56:59], v[60:63], v[64:79]
    v_mfma_f32_32x32x16_bf16 v[96:111], v[56:59], v[20:23], v[96:111]
    s_nop 7
    ds_read_b128 v[56:59], v6 offset:2048
    s_waitcnt lgkmcnt(0)
    v_mfma_f32_32x32x16_bf16 v[80:95], v[56:59], v[60:63], v[80:95]
    v_mfma_f32_32x32x16_bf16 v[112:127], v[56:59], v[20:23], v[112:127]
    s_nop 7
    ds_read_b64_tr_b16 v[60:61], v7 offset:1024
    ds_read_b64_tr_b16 v[62:63], v7 offset:1280
    ds_read_b128 v[56:59], v6 offset:32
    s_waitcnt lgkmcnt(0)
    v_mfma_f32_32x32x16_bf16 v[64:79], v[56:59], v[60:63], v[64:79]
    v_mfma_f32_32x32x16_bf16 v[96:111], v[56:59], v[20:23], v[96:111]
    s_nop 7
    ds_read_b128 v[56:59], v6 offset:2080
    s_waitcnt lgkmcnt(0)
    v_mfma_f32_32x32x16_bf16 v[80:95], v[56:59], v[60:63], v[80:95]
    v_mfma_f32_32x32x16_bf16 v[112:127], v[56:59], v[20:23], v[112:127]
    s_nop 7
    s_nop 7
    s_nop 15
    s_nop 3
    s_mul_i32 s15, s12, 8448
    v_lshlrev_b32 v5, 9, v3
    v_lshl_add_u32 v5, v2, 2, v5
    v_add_u32 v5, s15, v5
    v_add_u32 v5, 24576, v5
    ds_write_b32 v5, v64 offset:0
    ds_write_b32 v5, v65 offset:128
    ds_write_b32 v5, v66 offset:256
    ds_write_b32 v5, v67 offset:384
    ds_write_b32 v5, v68 offset:1024
    ds_write_b32 v5, v69 offset:1152
    ds_write_b32 v5, v70 offset:1280
    ds_write_b32 v5, v71 offset:1408
    ds_write_b32 v5, v72 offset:2048
    ds_write_b32 v5, v73 offset:2176
    ds_write_b32 v5, v74 offset:2304
    ds_write_b32 v5, v75 offset:2432
    ds_write_b32 v5, v76 offset:3072
    ds_write_b32 v5, v77 offset:3200
    ds_write_b32 v5, v78 offset:3328
    ds_write_b32 v5, v79 offset:3456
    ds_write_b32 v5, v80 offset:4096
    ds_write_b32 v5, v81 offset:4224
    ds_write_b32 v5, v82 offset:4352
    ds_write_b32 v5, v83 offset:4480
    ds_write_b32 v5, v84 offset:5120
    ds_write_b32 v5, v85 offset:5248
    ds_write_b32 v5, v86 offset:5376
    ds_write_b32 v5, v87 offset:5504
    ds_write_b32 v5, v88 offset:6144
    ds_write_b32 v5, v89 offset:6272
    ds_write_b32 v5, v90 offset:6400
    ds_write_b32 v5, v91 offset:6528
    ds_write_b32 v5, v92 offset:7168
    ds_write_b32 v5, v93 offset:7296
    ds_write_b32 v5, v94 offset:7424
    ds_write_b32 v5, v95 offset:7552
    v_lshlrev_b32 v6, 4, v3
    v_add_u32 v6, s15, v6
    v_add_u32 v6, 24576, v6
    ds_write_b32 v6, v96 offset:8192
    ds_write_b32 v6, v97 offset:8196
    ds_write_b32 v6, v98 offset:8200
    ds_write_b32 v6, v99 offset:8204
    ds_write_b32 v6, v100 offset:8224
    ds_write_b32 v6, v101 offset:8228
    ds_write_b32 v6, v102 offset:8232
    ds_write_b32 v6, v103 offset:8236
    ds_write_b32 v6, v104 offset:8256
    ds_write_b32 v6, v105 offset:8260
    ds_write_b32 v6, v106 offset:8264
    ds_write_b32 v6, v107 offset:8268
    ds_write_b32 v6, v108 offset:8288
    ds_write_b32 v6, v109 offset:8292
    ds_write_b32 v6, v110 offset:8296
    ds_write_b32 v6, v111 offset:8300
    ds_write_b32 v6, v112 offset:8320
    ds_write_b32 v6, v113 offset:8324
    ds_write_b32 v6, v114 offset:8328
    ds_write_b32 v6, v115 offset:8332
    ds_write_b32 v6, v116 offset:8352
    ds_write_b32 v6, v117 offset:8356
    ds_write_b32 v6, v118 offset:8360
    ds_write_b32 v6, v119 offset:8364
    ds_write_b32 v6, v120 offset:8384
    ds_write_b32 v6, v121 offset:8388
    ds_write_b32 v6, v122 offset:8392
    ds_write_b32 v6, v123 offset:8396
    ds_write_b32 v6, v124 offset:8416
    ds_write_b32 v6, v125 offset:8420
    ds_write_b32 v6, v126 offset:8424
    ds_write_b32 v6, v127 offset:8428
    s_waitcnt lgkmcnt(0)
    s_barrier
    s_lshl_b32 s30, s13, 3
    s_add_u32 s30, s30, s14
    s_mul_i32 s30, s30, 8448
    v_lshlrev_b32 v5, 2, v0
    ds_read_b32 v8, v5 offset:24576
    ds_read_b32 v9, v5 offset:33024
    ds_read_b32 v10, v5 offset:41472
    ds_read_b32 v11, v5 offset:49920
    s_waitcnt lgkmcnt(0)
    v_add_f32 v8, v8, v9
    v_add_f32 v10, v10, v11
    v_add_f32 v8, v8, v10
    s_add_u32 s31, s30, 0
    buffer_store_dword v8, v5, s[24:27], s31 offen
    ds_read_b32 v8, v5 offset:25600
    ds_read_b32 v9, v5 offset:34048
    ds_read_b32 v10, v5 offset:42496
    ds_read_b32 v11, v5 offset:50944
    s_waitcnt lgkmcnt(0)
    v_add_f32 v8, v8, v9
    v_add_f32 v10, v10, v11
    v_add_f32 v8, v8, v10
    s_add_u32 s31, s30, 1024
    buffer_store_dword v8, v5, s[24:27], s31 offen
    ds_read_b32 v8, v5 offset:26624
    ds_read_b32 v9, v5 offset:35072
    ds_read_b32 v10, v5 offset:43520
    ds_read_b32 v11, v5 offset:51968
    s_waitcnt lgkmcnt(0)
    v_add_f32 v8, v8, v9
    v_add_f32 v10, v10, v11
    v_add_f32 v8, v8, v10
    s_add_u32 s31, s30, 2048
    buffer_store_dword v8, v5, s[24:27], s31 offen
    ds_read_b32 v8, v5 offset:27648
    ds_read_b32 v9, v5 offset:36096
    ds_read_b32 v10, v5 offset:44544
    ds_read_b32 v11, v5 offset:52992
    s_waitcnt lgkmcnt(0)
    v_add_f32 v8, v8, v9
    v_add_f32 v10, v10, v11
    v_add_f32 v8, v8, v10
    s_add_u32 s31, s30, 3072
    buffer_store_dword v8, v5, s[24:27], s31 offen
    ds_read_b32 v8, v5 offset:28672
    ds_read_b32 v9, v5 offset:37120
    ds_read_b32 v10, v5 offset:45568
    ds_read_b32 v11, v5 offset:54016
    s_waitcnt lgkmcnt(0)
    v_add_f32 v8, v8, v9
    v_add_f32 v10, v10, v11
    v_add_f32 v8, v8, v10
    s_add_u32 s31, s30, 4096
    buffer_store_dword v8, v5, s[24:27], s31 offen
    ds_read_b32 v8, v5 offset:29696
    ds_read_b32 v9, v5 offset:38144
    ds_read_b32 v10, v5 offset:46592
    ds_read_b32 v11, v5 offset:55040
    s_waitcnt lgkmcnt(0)
    v_add_f32 v8, v8, v9
    v_add_f32 v10, v10, v11
    v_add_f32 v8, v8, v10
    s_add_u32 s31, s30, 5120
    buffer_store_dword v8, v5, s[24:27], s31 offen
    ds_read_b32 v8, v5 offset:30720
    ds_read_b32 v9, v5 offset:39168
    ds_read_b32 v10, v5 offset:47616
    ds_read_b32 v11, v5 offset:56064
    s_waitcnt lgkmcnt(0)
    v_add_f32 v8, v8, v9
    v_add_f32 v10, v10, v11
    v_add_f32 v8, v8, v10
    s_add_u32 s31, s30, 6144
    buffer_store_dword v8, v5, s[24:27], s31 offen
    ds_read_b32 v8, v5 offset:31744
    ds_read_b32 v9, v5 offset:40192
    ds_read_b32 v10, v5 offset:48640
    ds_read_b32 v11, v5 offset:57088
    s_waitcnt lgkmcnt(0)
    v_add_f32 v8, v8, v9
    v_add_f32 v10, v10, v11
    v_add_f32 v8, v8, v10
    s_add_u32 s31, s30, 7168
    buffer_store_dword v8, v5, s[24:27], s31 offen
    v_cmp_gt_u32 vcc, 64, v0
    s_and_saveexec_b64 s[42:43], vcc
    ds_read_b32 v8, v5 offset:32768
    ds_read_b32 v9, v5 offset:41216
    ds_read_b32 v10, v5 offset:49664
    ds_read_b32 v11, v5 offset:58112
    s_waitcnt lgkmcnt(0)
    v_add_f32 v8, v8, v9
    v_add_f32 v10, v10, v11
    v_add_f32 v8, v8, v10
    s_add_u32 s31, s30, 8192
    buffer_store_dword v8, v5, s[24:27], s31 offen
END_kv_kernel_1:
    s_endpgm
.globl ln1_kernel
.p2align 8
.type ln1_kernel,@function
ln1_kernel:
    s_cmp_ge_u32 s2, 512
    s_cbranch_scc1 END_ln1_kernel_1
    s_load_dwordx2 s[6:7], s[0:1], 96
    v_lshrrev_b32 v1, 6, v0
    s_nop 0
    v_readfirstlane_b32 s12, v1
    s_waitcnt lgkmcnt(0)
    s_lshl_b32 s13, s2, 2
    s_add_u32 s13, s13, s12
    s_add_u32 s16, s6, 0x1400000
    s_addc_u32 s17, s7, 0
    s_mov_b32 s18, 0x400000
    s_mov_b32 s19, 0x00020000
    s_add_u32 s20, s6, 0x1800000
    s_addc_u32 s21, s7, 0
    s_mov_b32 s22, 0x400000
    s_mov_b32 s23, 0x00020000
    v_and_b32 v1, 63, v0
    v_lshlrev_b32 v2, 4, v1
    s_lshl_b32 s40, s13, 11
    v_add_u32 v2, s40, v2
    buffer_load_dwordx4 v[8:11], v2, s[16:19], 0 offen
    buffer_load_dwordx4 v[12:15], v2, s[16:19], 0 offen offset:1024
    v_lshlrev_b32 v3, 2, v1
    s_waitcnt vmcnt(0)
    v_lshlrev_b32 v16, 16, v8
    v_and_b32 v17, 0xffff0000, v8
    v_lshlrev_b32 v18, 16, v9
    v_and_b32 v19, 0xffff0000, v9
    v_lshlrev_b32 v20, 16, v10
    v_and_b32 v21, 0xffff0000, v10
    v_lshlrev_b32 v22, 16, v11
    v_and_b32 v23, 0xffff0000, v11
    v_lshlrev_b32 v24, 16, v12
    v_and_b32 v25, 0xffff0000, v12
    v_lshlrev_b32 v26, 16, v13
    v_and_b32 v27, 0xffff0000, v13
    v_lshlrev_b32 v28, 16, v14
    v_and_b32 v29, 0xffff0000, v14
    v_lshlrev_b32 v30, 16, v15
    v_and_b32 v31, 0xffff0000, v15
    v_add_f32 v4, v16, v17
    v_add_f32 v4, v4, v18
    v_add_f32 v4, v4, v19
    v_add_f32 v4, v4, v20
    v_add_f32 v4, v4, v21
    v_add_f32 v4, v4, v22
    v_add_f32 v4, v4, v23
    v_add_f32 v4, v4, v24
    v_add_f32 v4, v4, v25
    v_add_f32 v4, v4, v26
    v_add_f32 v4, v4, v27
    v_add_f32 v4, v4, v28
    v_add_f32 v4, v4, v29
    v_add_f32 v4, v4, v30
    v_add_f32 v4, v4, v31
    v_xor_b32 v5, 4, v3
    ds_bpermute_b32 v5, v5, v4
    s_waitcnt lgkmcnt(0)
    v_add_f32 v4, v4, v5
    v_xor_b32 v5, 8, v3
    ds_bpermute_b32 v5, v5, v4
    s_waitcnt lgkmcnt(0)
    v_add_f32 v4, v4, v5
    v_xor_b32 v5, 16, v3
    ds_bpermute_b32 v5, v5, v4
    s_waitcnt lgkmcnt(0)
    v_add_f32 v4, v4, v5
    v_xor_b32 v5, 32, v3
    ds_bpermute_b32 v5, v5, v4
    s_waitcnt lgkmcnt(0)
    v_add_f32 v4, v4, v5
    v_xor_b32 v5, 64, v3
    ds_bpermute_b32 v5, v5, v4
    s_waitcnt lgkmcnt(0)
    v_add_f32 v4, v4, v5
    v_xor_b32 v5, 128, v3
    ds_bpermute_b32 v5, v5, v4
    s_waitcnt lgkmcnt(0)
    v_add_f32 v4, v4, v5
    v_mul_f32 v4, 0x3a800000, v4
    v_sub_f32 v5, v16, v4
    v_mul_f32 v6, v5, v5
    v_sub_f32 v5, v17, v4
    v_fmac_f32 v6, v5, v5
    v_sub_f32 v5, v18, v4
    v_fmac_f32 v6, v5, v5
    v_sub_f32 v5, v19, v4
    v_fmac_f32 v6, v5, v5
    v_sub_f32 v5, v20, v4
    v_fmac_f32 v6, v5, v5
    v_sub_f32 v5, v21, v4
    v_fmac_f32 v6, v5, v5
    v_sub_f32 v5, v22, v4
    v_fmac_f32 v6, v5, v5
    v_sub_f32 v5, v23, v4
    v_fmac_f32 v6, v5, v5
    v_sub_f32 v5, v24, v4
    v_fmac_f32 v6, v5, v5
    v_sub_f32 v5, v25, v4
    v_fmac_f32 v6, v5, v5
    v_sub_f32 v5, v26, v4
    v_fmac_f32 v6, v5, v5
    v_sub_f32 v5, v27, v4
    v_fmac_f32 v6, v5, v5
    v_sub_f32 v5, v28, v4
    v_fmac_f32 v6, v5, v5
    v_sub_f32 v5, v29, v4
    v_fmac_f32 v6, v5, v5
    v_sub_f32 v5, v30, v4
    v_fmac_f32 v6, v5, v5
    v_sub_f32 v5, v31, v4
    v_fmac_f32 v6, v5, v5
    v_xor_b32 v5, 4, v3
    ds_bpermute_b32 v5, v5, v6
    s_waitcnt lgkmcnt(0)
    v_add_f32 v6, v6, v5
    v_xor_b32 v5, 8, v3
    ds_bpermute_b32 v5, v5, v6
    s_waitcnt lgkmcnt(0)
    v_add_f32 v6, v6, v5
    v_xor_b32 v5, 16, v3
    ds_bpermute_b32 v5, v5, v6
    s_waitcnt lgkmcnt(0)
    v_add_f32 v6, v6, v5
    v_xor_b32 v5, 32, v3
    ds_bpermute_b32 v5, v5, v6
    s_waitcnt lgkmcnt(0)
    v_add_f32 v6, v6, v5
    v_xor_b32 v5, 64, v3
    ds_bpermute_b32 v5, v5, v6
    s_waitcnt lgkmcnt(0)
    v_add_f32 v6, v6, v5
    v_xor_b32 v5, 128, v3
    ds_bpermute_b32 v5, v5, v6
    s_waitcnt lgkmcnt(0)
    v_add_f32 v6, v6, v5
    v_mul_f32 v6, 0x3a800000, v6
    v_cvt_pk_bf16_f32 v4, v4, v4
    v_lshlrev_b32 v4, 16, v4
    v_cvt_pk_bf16_f32 v6, v6, v6
    v_lshlrev_b32 v6, 16, v6
    v_add_f32 v6, 0x3727c5ac, v6
    v_cvt_pk_bf16_f32 v6, v6, v6
    v_lshlrev_b32 v6, 16, v6
    v_sqrt_f32 v6, v6
    s_nop 0
    v_cvt_pk_bf16_f32 v6, v6, v6
    v_lshlrev_b32 v6, 16, v6
    v_rcp_f32 v7, v6
    s_nop 0
    v_sub_f32 v16, v16, v4
    v_cvt_pk_bf16_f32 v16, v16, v16
    v_lshlrev_b32 v16, 16, v16
    v_mul_f32 v5, v16, v7
    v_fma_f32 v32, -v5, v6, v16
    v_fma_f32 v16, v32, v7, v5
    v_sub_f32 v17, v17, v4
    v_cvt_pk_bf16_f32 v17, v17, v17
    v_lshlrev_b32 v17, 16, v17
    v_mul_f32 v5, v17, v7
    v_fma_f32 v32, -v5, v6, v17
    v_fma_f32 v17, v32, v7, v5
    v_sub_f32 v18, v18, v4
    v_cvt_pk_bf16_f32 v18, v18, v18
    v_lshlrev_b32 v18, 16, v18
    v_mul_f32 v5, v18, v7
    v_fma_f32 v32, -v5, v6, v18
    v_fma_f32 v18, v32, v7, v5
    v_sub_f32 v19, v19, v4
    v_cvt_pk_bf16_f32 v19, v19, v19
    v_lshlrev_b32 v19, 16, v19
    v_mul_f32 v5, v19, v7
    v_fma_f32 v32, -v5, v6, v19
    v_fma_f32 v19, v32, v7, v5
    v_sub_f32 v20, v20, v4
    v_cvt_pk_bf16_f32 v20, v20, v20
    v_lshlrev_b32 v20, 16, v20
    v_mul_f32 v5, v20, v7
    v_fma_f32 v32, -v5, v6, v20
    v_fma_f32 v20, v32, v7, v5
    v_sub_f32 v21, v21, v4
    v_cvt_pk_bf16_f32 v21, v21, v21
    v_lshlrev_b32 v21, 16, v21
    v_mul_f32 v5, v21, v7
    v_fma_f32 v32, -v5, v6, v21
    v_fma_f32 v21, v32, v7, v5
    v_sub_f32 v22, v22, v4
    v_cvt_pk_bf16_f32 v22, v22, v22
    v_lshlrev_b32 v22, 16, v22
    v_mul_f32 v5, v22, v7
    v_fma_f32 v32, -v5, v6, v22
    v_fma_f32 v22, v32, v7, v5
    v_sub_f32 v23, v23, v4
    v_cvt_pk_bf16_f32 v23, v23, v23
    v_lshlrev_b32 v23, 16, v23
    v_mul_f32 v5, v23, v7
    v_fma_f32 v32, -v5, v6, v23
    v_fma_f32 v23, v32, v7, v5
    v_sub_f32 v24, v24, v4
    v_cvt_pk_bf16_f32 v24, v24, v24
    v_lshlrev_b32 v24, 16, v24
    v_mul_f32 v5, v24, v7
    v_fma_f32 v32, -v5, v6, v24
    v_fma_f32 v24, v32, v7, v5
    v_sub_f32 v25, v25, v4
    v_cvt_pk_bf16_f32 v25, v25, v25
    v_lshlrev_b32 v25, 16, v25
    v_mul_f32 v5, v25, v7
    v_fma_f32 v32, -v5, v6, v25
    v_fma_f32 v25, v32, v7, v5
    v_sub_f32 v26, v26, v4
    v_cvt_pk_bf16_f32 v26, v26, v26
    v_lshlrev_b32 v26, 16, v26
    v_mul_f32 v5, v26, v7
    v_fma_f32 v32, -v5, v6, v26
    v_fma_f32 v26, v32, v7, v5
    v_sub_f32 v27, v27, v4
    v_cvt_pk_bf16_f32 v27, v27, v27
    v_lshlrev_b32 v27, 16, v27
    v_mul_f32 v5, v27, v7
    v_fma_f32 v32, -v5, v6, v27
    v_fma_f32 v27, v32, v7, v5
    v_sub_f32 v28, v28, v4
    v_cvt_pk_bf16_f32 v28, v28, v28
    v_lshlrev_b32 v28, 16, v28
    v_mul_f32 v5, v28, v7
    v_fma_f32 v32, -v5, v6, v28
    v_fma_f32 v28, v32, v7, v5
    v_sub_f32 v29, v29, v4
    v_cvt_pk_bf16_f32 v29, v29, v29
    v_lshlrev_b32 v29, 16, v29
    v_mul_f32 v5, v29, v7
    v_fma_f32 v32, -v5, v6, v29
    v_fma_f32 v29, v32, v7, v5
    v_sub_f32 v30, v30, v4
    v_cvt_pk_bf16_f32 v30, v30, v30
    v_lshlrev_b32 v30, 16, v30
    v_mul_f32 v5, v30, v7
    v_fma_f32 v32, -v5, v6, v30
    v_fma_f32 v30, v32, v7, v5
    v_sub_f32 v31, v31, v4
    v_cvt_pk_bf16_f32 v31, v31, v31
    v_lshlrev_b32 v31, 16, v31
    v_mul_f32 v5, v31, v7
    v_fma_f32 v32, -v5, v6, v31
    v_fma_f32 v31, v32, v7, v5
    v_cvt_pk_bf16_f32 v8, v16, v17
    v_cvt_pk_bf16_f32 v9, v18, v19
    v_cvt_pk_bf16_f32 v10, v20, v21
    v_cvt_pk_bf16_f32 v11, v22, v23
    v_cvt_pk_bf16_f32 v12, v24, v25
    v_cvt_pk_bf16_f32 v13, v26, v27
    v_cvt_pk_bf16_f32 v14, v28, v29
    v_cvt_pk_bf16_f32 v15, v30, v31
    buffer_store_dwordx4 v[8:11], v2, s[20:23], 0 offen
    buffer_store_dwordx4 v[12:15], v2, s[20:23], 0 offen offset:1024
END_ln1_kernel_1:
    s_endpgm
.globl g4at_kernel
.p2align 8
.type g4at_kernel,@function
g4at_kernel:
    s_cmp_ge_u32 s2, 224
    s_cbranch_scc1 BODY2_g4at_kernel_1
    s_cmp_ge_u32 s2, 224
    s_cbranch_scc1 END_gemm4_kernel_1
    v_lshrrev_b32 v1, 6, v0
    s_nop 0
    v_readfirstlane_b32 s30, v1
    s_load_dwordx2 s[46:47], s[0:1], 56
    s_load_dwordx2 s[48:49], s[0:1], 96
    s_load_dwordx2 s[74:75], s[0:1], 64
    s_load_dwordx2 s[76:77], s[0:1], 24
    s_waitcnt lgkmcnt(0)
    s_add_u32 s4, s48, 0x1800000
    s_addc_u32 s5, s49, 0
    s_mov_b32 s6, 0x400000
    s_mov_b32 s7, 0x00020000
    s_add_u32 s8, s46, 0x0
    s_addc_u32 s9, s47, 0
    s_mov_b32 s10, 0x700000
    s_mov_b32 s11, 0x00020000
    s_add_u32 s12, s48, 0x1c00000
    s_addc_u32 s13, s49, 0
    s_mov_b32 s14, 0xe00000
    s_mov_b32 s15, 0x00020000
    s_mov_b32 s24, 2048
    s_mov_b32 s25, 7168
    s_mov_b32 s26, 7168
    s_mov_b32 s27, 16
    s_and_b32 s28, s2, 7
    s_lshl_b32 s28, s28, 8
    s_lshr_b32 s29, s2, 3
    s_lshl_b32 s29, s29, 7
    s_add_u32 s64, s74, 0x0
    s_addc_u32 s65, s75, 0
    s_mov_b32 s66, 0x700000
    s_mov_b32 s67, 0x00020000
    s_add_u32 s68, s76, 0x0
    s_addc_u32 s69, s77, 0
    s_mov_b32 s70, 0x200000
    s_mov_b32 s71, 0x00020000
    v_and_b32 v8, 63, v0
    v_cmp_gt_u32 vcc, 2, v8
    v_lshlrev_b32 v8, 7, v8
    v_mov_b32 v9, 0x7ffffff0
    v_cndmask_b32 v8, v9, v8, vcc
    s_mul_i32 s72, s2, 8
    s_add_u32 s72, s72, s30
    s_mul_i32 s72, s72, s27
    s_lshl_b32 s72, s72, 8
    v_and_b32 v1, 63, v0
    v_lshrrev_b32 v2, 3, v1
    s_mul_i32 s38, s30, 32
    v_add_u32 v2, s38, v2
    v_mul_lo_u32 v2, v2, s24
    v_and_b32 v3, 7, v1
    v_lshrrev_b32 v4, 4, v1
    v_xor_b32 v3, v3, v4
    s_mul_i32 s38, s30, 4
    s_add_u32 s38, s38, 0
    s_and_b32 s38, s38, 1
    s_lshl_b32 s38, s38, 2
    v_xor_b32 v4, s38, v3
    v_lshl_add_u32 v16, v4, 4, v2
    s_lshl_b32 s38, s24, 3
    v_add_u32 v2, s38, v2
    s_mul_i32 s38, s30, 4
    s_add_u32 s38, s38, 1
    s_and_b32 s38, s38, 1
    s_lshl_b32 s38, s38, 2
    v_xor_b32 v4, s38, v3
    v_lshl_add_u32 v17, v4, 4, v2
    s_lshl_b32 s38, s24, 3
    v_add_u32 v2, s38, v2
    s_mul_i32 s38, s30, 4
    s_add_u32 s38, s38, 2
    s_and_b32 s38, s38, 1
    s_lshl_b32 s38, s38, 2
    v_xor_b32 v4, s38, v3
    v_lshl_add_u32 v18, v4, 4, v2
    s_lshl_b32 s38, s24, 3
    v_add_u32 v2, s38, v2
    s_mul_i32 s38, s30, 4
    s_add_u32 s38, s38, 3
    s_and_b32 s38, s38, 1
    s_lshl_b32 s38, s38, 2
    v_xor_b32 v4, s38, v3
    v_lshl_add_u32 v19, v4, 4, v2
    v_lshrrev_b32 v2, 4, v1
    s_mul_i32 s38, s30, 8
    v_add_u32 v3, s38, v2
    v_mul_lo_u32 v3, v3, s25
    v_lshlrev_b32 v2, 2, v2
    v_and_b32 v4, 15, v1
    v_xor_b32 v4, v4, v2
    v_lshl_add_u32 v20, v4, 4, v3
    s_lshl_b32 s38, s25, 2
    v_add_u32 v3, s38, v3
    v_lshl_add_u32 v21, v4, 4, v3
    s_mul_i32 s36, s30, 4096
    s_mul_i32 s37, s30, 2048
    s_add_u32 s37, s37, 32768
    s_mul_i32 s32, s28, s24
    s_lshl_b32 s33, s29, 1
    s_lshl_b32 s42, s25, 6
    s_mov_b32 s31, 0
    s_mov_b32 s35, 0
    s_add_u32 m0, s35, s36
    s_nop 0
    buffer_load_dwordx4 v16, s[4:7], s32 offen lds
    s_add_u32 m0, m0, 1024
    s_nop 0
    buffer_load_dwordx4 v17, s[4:7], s32 offen lds
    s_add_u32 m0, m0, 1024
    s_nop 0
    buffer_load_dwordx4 v18, s[4:7], s32 offen lds
    s_add_u32 m0, m0, 1024
    s_nop 0
    buffer_load_dwordx4 v19, s[4:7], s32 offen lds
    s_add_u32 m0, s35, s37
    s_nop 0
    buffer_load_dwordx4 v20, s[8:11], s33 offen lds
    s_add_u32 m0, m0, 1024
    s_nop 0
    buffer_load_dwordx4 v21, s[8:11], s33 offen lds
    buffer_load_dword v9, v8, s[64:67], s72 offen
    buffer_load_dword v9, v8, s[68:71], s72 offen
    s_add_u32 s72, s72, 256
    s_add_u32 s32, s32, 128
    s_add_u32 s33, s33, s42
    s_add_u32 s31, s31, 1
    s_mov_b32 s35, 49152
    s_add_u32 m0, s35, s36
    s_nop 0
    buffer_load_dwordx4 v16, s[4:7], s32 offen lds
    s_add_u32 m0, m0, 1024
    s_nop 0
    buffer_load_dwordx4 v17, s[4:7], s32 offen lds
    s_add_u32 m0, m0, 1024
    s_nop 0
    buffer_load_dwordx4 v18, s[4:7], s32 offen lds
    s_add_u32 m0, m0, 1024
    s_nop 0
    buffer_load_dwordx4 v19, s[4:7], s32 offen lds
    s_add_u32 m0, s35, s37
    s_nop 0
    buffer_load_dwordx4 v20, s[8:11], s33 offen lds
    s_add_u32 m0, m0, 1024
    s_nop 0
    buffer_load_dwordx4 v21, s[8:11], s33 offen lds
    buffer_load_dword v9, v8, s[64:67], s72 offen
    buffer_load_dword v9, v8, s[68:71], s72 offen
    s_add_u32 s72, s72, 256
    s_add_u32 s32, s32, 128
    s_add_u32 s33, s33, s42
    s_add_u32 s31, s31, 1
    s_mov_b32 s79, s42
    v_and_b32 v1, 63, v0
    s_and_b32 s42, s30, 3
    s_lshr_b32 s43, s30, 2
    v_and_b32 v2, 31, v1
    s_mul_i32 s38, s42, 64
    v_add_u32 v2, s38, v2
    v_lshlrev_b32 v2, 7, v2
    v_lshrrev_b32 v3, 5, v1
    v_bfe_u32 v4, v1, 1, 3
    v_xor_b32 v3, v3, v4
    v_xor_b32 v4, 0, v3
    v_lshl_add_u32 v10, v4, 4, v2
    v_xor_b32 v4, 2, v3
    v_lshl_add_u32 v11, v4, 4, v2
    v_xor_b32 v4, 4, v3
    v_lshl_add_u32 v12, v4, 4, v2
    v_xor_b32 v4, 6, v3
    v_lshl_add_u32 v13, v4, 4, v2
    v_bfe_u32 v2, v1, 2, 2
    v_lshrrev_b32 v3, 5, v1
    v_lshl_add_u32 v3, v3, 3, v2
    v_mul_u32_u24 v3, 256, v3
    v_bfe_u32 v4, v1, 4, 1
    v_lshl_add_u32 v3, v4, 5, v3
    v_and_b32 v4, 3, v1
    v_lshl_add_u32 v3, v4, 3, v3
    v_add_u32 v3, 32768, v3
    s_mul_i32 s38, s43, 2
    s_add_u32 s38, s38, 0
    v_xor_b32 v4, s38, v2
    v_lshl_add_u32 v14, v4, 6, v3
    s_mul_i32 s38, s43, 2
    s_add_u32 s38, s38, 1
    v_xor_b32 v4, s38, v2
    v_lshl_add_u32 v15, v4, 6, v3
    s_mov_b32 s42, s79
    v_mov_b32 v96, 0
    v_mov_b32 v97, 0
    v_mov_b32 v98, 0
    v_mov_b32 v99, 0
    v_mov_b32 v100, 0
    v_mov_b32 v101, 0
    v_mov_b32 v102, 0
    v_mov_b32 v103, 0
    v_mov_b32 v104, 0
    v_mov_b32 v105, 0
    v_mov_b32 v106, 0
    v_mov_b32 v107, 0
    v_mov_b32 v108, 0
    v_mov_b32 v109, 0
    v_mov_b32 v110, 0
    v_mov_b32 v111, 0
    v_mov_b32 v112, 0
    v_mov_b32 v113, 0
    v_mov_b32 v114, 0
    v_mov_b32 v115, 0
    v_mov_b32 v116, 0
    v_mov_b32 v117, 0
    v_mov_b32 v118, 0
    v_mov_b32 v119, 0
    v_mov_b32 v120, 0
    v_mov_b32 v121, 0
    v_mov_b32 v122, 0
    v_mov_b32 v123, 0
    v_mov_b32 v124, 0
    v_mov_b32 v125, 0
    v_mov_b32 v126, 0
    v_mov_b32 v127, 0
    v_mov_b32 v128, 0
    v_mov_b32 v129, 0
    v_mov_b32 v130, 0
    v_mov_b32 v131, 0
    v_mov_b32 v132, 0
    v_mov_b32 v133, 0
    v_mov_b32 v134, 0
    v_mov_b32 v135, 0
    v_mov_b32 v136, 0
    v_mov_b32 v137, 0
    v_mov_b32 v138, 0
    v_mov_b32 v139, 0
    v_mov_b32 v140, 0
    v_mov_b32 v141, 0
    v_mov_b32 v142, 0
    v_mov_b32 v143, 0
    v_mov_b32 v144, 0
    v_mov_b32 v145, 0
    v_mov_b32 v146, 0
    v_mov_b32 v147, 0
    v_mov_b32 v148, 0
    v_mov_b32 v149, 0
    v_mov_b32 v150, 0
    v_mov_b32 v151, 0
    v_mov_b32 v152, 0
    v_mov_b32 v153, 0
    v_mov_b32 v154, 0
    v_mov_b32 v155, 0
    v_mov_b32 v156, 0
    v_mov_b32 v157, 0
    v_mov_b32 v158, 0
    v_mov_b32 v159, 0
    s_mov_b32 s35, 98304
    s_mov_b32 s34, 0
    s_mov_b32 s43, 0
    s_waitcnt vmcnt(8)
    s_barrier
    s_cmp_ge_u32 s30, 4
    s_cbranch_scc1 GRPB_gemm4_kernel_2
PPL_gemm4_kernel_4:
    ds_read_b128 v[24:27], v10 offset:0
    ds_read_b128 v[40:43], v10 offset:4096
    ds_read_b64_tr_b16 v[56:57], v14 offset:0
    ds_read_b64_tr_b16 v[58:59], v14 offset:1024
    ds_read_b64_tr_b16 v[72:73], v15 offset:0
    ds_read_b64_tr_b16 v[74:75], v15 offset:1024
    ds_read_b128 v[28:31], v11 offset:0
    ds_read_b128 v[44:47], v11 offset:4096
    ds_read_b64_tr_b16 v[60:61], v14 offset:4096
    ds_read_b64_tr_b16 v[62:63], v14 offset:5120
    ds_read_b64_tr_b16 v[76:77], v15 offset:4096
    ds_read_b64_tr_b16 v[78:79], v15 offset:5120
    ds_read_b128 v[32:35], v12 offset:0
    ds_read_b128 v[48:51], v12 offset:4096
    ds_read_b64_tr_b16 v[64:65], v14 offset:8192
    ds_read_b64_tr_b16 v[66:67], v14 offset:9216
    ds_read_b64_tr_b16 v[80:81], v15 offset:8192
    ds_read_b64_tr_b16 v[82:83], v15 offset:9216
    ds_read_b128 v[36:39], v13 offset:0
    ds_read_b128 v[52:55], v13 offset:4096
    ds_read_b64_tr_b16 v[68:69], v14 offset:12288
    ds_read_b64_tr_b16 v[70:71], v14 offset:13312
    ds_read_b64_tr_b16 v[84:85], v15 offset:12288
    ds_read_b64_tr_b16 v[86:87], v15 offset:13312
    s_cmp_ge_u32 s31, s27
    s_cbranch_scc1 PPN_gemm4_kernel_5
    s_add_u32 m0, s35, s36
    s_nop 0
    buffer_load_dwordx4 v16, s[4:7], s32 offen lds
    s_add_u32 m0, m0, 1024
    s_nop 0
    buffer_load_dwordx4 v17, s[4:7], s32 offen lds
    s_add_u32 m0, m0, 1024
    s_nop 0
    buffer_load_dwordx4 v18, s[4:7], s32 offen lds
    s_add_u32 m0, m0, 1024
    s_nop 0
    buffer_load_dwordx4 v19, s[4:7], s32 offen lds
    s_add_u32 m0, s35, s37
    s_nop 0
    buffer_load_dwordx4 v20, s[8:11], s33 offen lds
    s_add_u32 m0, m0, 1024
    s_nop 0
    buffer_load_dwordx4 v21, s[8:11], s33 offen lds
    buffer_load_dword v9, v8, s[64:67], s72 offen
    buffer_load_dword v9, v8, s[68:71], s72 offen
    s_add_u32 s72, s72, 256
    s_add_u32 s32, s32, 128
    s_add_u32 s33, s33, s42
    s_add_u32 s31, s31, 1
PPN_gemm4_kernel_5:
    s_waitcnt lgkmcnt(0)
    s_barrier
    s_setprio 1
    v_mfma_f32_32x32x16_bf16 v[96:111], v[56:59], v[24:27], v[96:111]
    v_mfma_f32_32x32x16_bf16 v[112:127], v[56:59], v[40:43], v[112:127]
    v_mfma_f32_32x32x16_bf16 v[128:143], v[72:75], v[24:27], v[128:143]
    v_mfma_f32_32x32x16_bf16 v[144:159], v[72:75], v[40:43], v[144:159]
    v_mfma_f32_32x32x16_bf16 v[96:111], v[60:63], v[28:31], v[96:111]
    v_mfma_f32_32x32x16_bf16 v[112:127], v[60:63], v[44:47], v[112:127]
    v_mfma_f32_32x32x16_bf16 v[128:143], v[76:79], v[28:31], v[128:143]
    v_mfma_f32_32x32x16_bf16 v[144:159], v[76:79], v[44:47], v[144:159]
    v_mfma_f32_32x32x16_bf16 v[96:111], v[64:67], v[32:35], v[96:111]
    v_mfma_f32_32x32x16_bf16 v[112:127], v[64:67], v[48:51], v[112:127]
    v_mfma_f32_32x32x16_bf16 v[128:143], v[80:83], v[32:35], v[128:143]
    v_mfma_f32_32x32x16_bf16 v[144:159], v[80:83], v[48:51], v[144:159]
    v_mfma_f32_32x32x16_bf16 v[96:111], v[68:71], v[36:39], v[96:111]
    v_mfma_f32_32x32x16_bf16 v[112:127], v[68:71], v[52:55], v[112:127]
    v_mfma_f32_32x32x16_bf16 v[128:143], v[84:87], v[36:39], v[128:143]
    v_mfma_f32_32x32x16_bf16 v[144:159], v[84:87], v[52:55], v[144:159]
    s_setprio 0
    s_mov_b32 s39, s34
    s_add_u32 s34, s34, 49152
    s_cmp_eq_u32 s34, 147456
    s_cselect_b32 s34, 0, s34
    s_sub_u32 s38, s34, s39
    v_add_u32 v10, s38, v10
    v_add_u32 v11, s38, v11
    v_add_u32 v12, s38, v12
    v_add_u32 v13, s38, v13
    v_add_u32 v14, s38, v14
    v_add_u32 v15, s38, v15
    s_add_u32 s35, s35, 49152
    s_cmp_eq_u32 s35, 147456
    s_cselect_b32 s35, 0, s35
    s_add_u32 s43, s43, 1
    s_add_u32 s38, s43, 2
    s_cmp_eq_u32 s38, s31
    s_cbranch_scc1 PX0_gemm4_kernel_8
    s_waitcnt vmcnt(0)
    s_branch PX1_gemm4_kernel_9
PX0_gemm4_kernel_8:
    s_waitcnt vmcnt(8)
PX1_gemm4_kernel_9:
    s_barrier
    s_cmp_lt_u32 s43, s27
    s_cbranch_scc1 PPL_gemm4_kernel_4
    s_barrier
    s_branch PPD_gemm4_kernel_3
GRPB_gemm4_kernel_2:
    s_barrier
PPL_gemm4_kernel_10:
    ds_read_b128 v[24:27], v10 offset:0
    ds_read_b128 v[40:43], v10 offset:4096
    ds_read_b64_tr_b16 v[56:57], v14 offset:0
    ds_read_b64_tr_b16 v[58:59], v14 offset:1024
    ds_read_b64_tr_b16 v[72:73], v15 offset:0
    ds_read_b64_tr_b16 v[74:75], v15 offset:1024
    ds_read_b128 v[28:31], v11 offset:0
    ds_read_b128 v[44:47], v11 offset:4096
    ds_read_b64_tr_b16 v[60:61], v14 offset:4096
    ds_read_b64_tr_b16 v[62:63], v14 offset:5120
    ds_read_b64_tr_b16 v[76:77], v15 offset:4096
    ds_read_b64_tr_b16 v[78:79], v15 offset:5120
    ds_read_b128 v[32:35], v12 offset:0
    ds_read_b128 v[48:51], v12 offset:4096
    ds_read_b64_tr_b16 v[64:65], v14 offset:8192
    ds_read_b64_tr_b16 v[66:67], v14 offset:9216
    ds_read_b64_tr_b16 v[80:81], v15 offset:8192
    ds_read_b64_tr_b16 v[82:83], v15 offset:9216
    ds_read_b128 v[36:39], v13 offset:0
    ds_read_b128 v[52:55], v13 offset:4096
    ds_read_b64_tr_b16 v[68:69], v14 offset:12288
    ds_read_b64_tr_b16 v[70:71], v14 offset:13312
    ds_read_b64_tr_b16 v[84:85], v15 offset:12288
    ds_read_b64_tr_b16 v[86:87], v15 offset:13312
    s_cmp_ge_u32 s31, s27
    s_cbranch_scc1 PPN_gemm4_kernel_11
    s_add_u32 m0, s35, s36
    s_nop 0
    buffer_load_dwordx4 v16, s[4:7], s32 offen lds
    s_add_u32 m0, m0, 1024
    s_nop 0
    buffer_load_dwordx4 v17, s[4:7], s32 offen lds
    s_add_u32 m0, m0, 1024
    s_nop 0
    buffer_load_dwordx4 v18, s[4:7], s32 offen lds
    s_add_u32 m0, m0, 1024
    s_nop 0
    buffer_load_dwordx4 v19, s[4:7], s32 offen lds
    s_add_u32 m0, s35, s37
    s_nop 0
    buffer_load_dwordx4 v20, s[8:11], s33 offen lds
    s_add_u32 m0, m0, 1024
    s_nop 0
    buffer_load_dwordx4 v21, s[8:11], s33 offen lds
    buffer_load_dword v9, v8, s[64:67], s72 offen
    buffer_load_dword v9, v8, s[68:71], s72 offen
    s_add_u32 s72, s72, 256
    s_add_u32 s32, s32, 128
    s_add_u32 s33, s33, s42
    s_add_u32 s31, s31, 1
PPN_gemm4_kernel_11:
    s_add_u32 s38, s43, 3
    s_cmp_eq_u32 s38, s31
    s_cbranch_scc1 PW0_gemm4_kernel_12
    s_waitcnt vmcnt(0) lgkmcnt(0)
    s_branch PW1_gemm4_kernel_13
PW0_gemm4_kernel_12:
    s_waitcnt vmcnt(8) lgkmcnt(0)
PW1_gemm4_kernel_13:
    s_barrier
    s_setprio 1
    v_mfma_f32_32x32x16_bf16 v[96:111], v[56:59], v[24:27], v[96:111]
    v_mfma_f32_32x32x16_bf16 v[112:127], v[56:59], v[40:43], v[112:127]
    v_mfma_f32_32x32x16_bf16 v[128:143], v[72:75], v[24:27], v[128:143]
    v_mfma_f32_32x32x16_bf16 v[144:159], v[72:75], v[40:43], v[144:159]
    v_mfma_f32_32x32x16_bf16 v[96:111], v[60:63], v[28:31], v[96:111]
    v_mfma_f32_32x32x16_bf16 v[112:127], v[60:63], v[44:47], v[112:127]
    v_mfma_f32_32x32x16_bf16 v[128:143], v[76:79], v[28:31], v[128:143]
    v_mfma_f32_32x32x16_bf16 v[144:159], v[76:79], v[44:47], v[144:159]
    v_mfma_f32_32x32x16_bf16 v[96:111], v[64:67], v[32:35], v[96:111]
    v_mfma_f32_32x32x16_bf16 v[112:127], v[64:67], v[48:51], v[112:127]
    v_mfma_f32_32x32x16_bf16 v[128:143], v[80:83], v[32:35], v[128:143]
    v_mfma_f32_32x32x16_bf16 v[144:159], v[80:83], v[48:51], v[144:159]
    v_mfma_f32_32x32x16_bf16 v[96:111], v[68:71], v[36:39], v[96:111]
    v_mfma_f32_32x32x16_bf16 v[112:127], v[68:71], v[52:55], v[112:127]
    v_mfma_f32_32x32x16_bf16 v[128:143], v[84:87], v[36:39], v[128:143]
    v_mfma_f32_32x32x16_bf16 v[144:159], v[84:87], v[52:55], v[144:159]
    s_setprio 0
    s_mov_b32 s39, s34
    s_add_u32 s34, s34, 49152
    s_cmp_eq_u32 s34, 147456
    s_cselect_b32 s34, 0, s34
    s_sub_u32 s38, s34, s39
    v_add_u32 v10, s38, v10
    v_add_u32 v11, s38, v11
    v_add_u32 v12, s38, v12
    v_add_u32 v13, s38, v13
    v_add_u32 v14, s38, v14
    v_add_u32 v15, s38, v15
    s_add_u32 s35, s35, 49152
    s_cmp_eq_u32 s35, 147456
    s_cselect_b32 s35, 0, s35
    s_add_u32 s43, s43, 1
    s_barrier
    s_cmp_lt_u32 s43, s27
    s_cbranch_scc1 PPL_gemm4_kernel_10
PPD_gemm4_kernel_3:
    s_sub_u32 s38, 0, s34
    v_add_u32 v10, s38, v10
    v_add_u32 v11, s38, v11
    v_add_u32 v12, s38, v12
    v_add_u32 v13, s38, v13
    v_add_u32 v14, s38, v14
    v_add_u32 v15, s38, v15
    v_and_b32 v1, 63, v0
    v_lshrrev_b32 v2, 4, v1
    s_mul_i32 s38, s30, 32
    v_add_u32 v2, s38, v2
    v_and_b32 v3, 15, v1
    v_and_b32 v4, 7, v2
    v_lshlrev_b32 v5, 1, v3
    v_xor_b32 v4, v4, v5
    v_mul_u32_u24 v5, 512, v2
    v_lshl_add_u32 v5, v4, 4, v5
    v_add_u32 v4, s28, v2
    v_mul_lo_u32 v6, v4, s26
    v_lshl_add_u32 v6, v3, 4, v6
    s_lshl_b32 s38, s29, 1
    v_add_u32 v6, s38, v6
    v_lshlrev_b32 v7, 2, v4
    s_nop 15
    s_nop 7
    s_and_b32 s42, s30, 3
    s_lshr_b32 s43, s30, 2
    v_and_b32 v1, 31, v0
    s_mul_i32 s38, s42, 64
    v_add_u32 v1, s38, v1
    v_mul_u32_u24 v2, 512, v1
    v_and_b32 v1, 7, v0
    v_bfe_u32 v3, v0, 5, 1
    v_xor_b32 v1, v1, v3
    s_mul_i32 s38, s43, 16
    v_xor_b32 v1, s38, v1
    v_lshl_add_u32 v2, v1, 4, v2
    v_xor_b32 v1, 0, v2
    ds_write_b128 v1, v[96:99] offset:0
    v_xor_b32 v1, 32, v2
    ds_write_b128 v1, v[100:103] offset:0
    v_xor_b32 v1, 64, v2
    ds_write_b128 v1, v[104:107] offset:0
    v_xor_b32 v1, 96, v2
    ds_write_b128 v1, v[108:111] offset:0
    v_xor_b32 v1, 128, v2
    ds_write_b128 v1, v[128:131] offset:0
    v_xor_b32 v1, 160, v2
    ds_write_b128 v1, v[132:135] offset:0
    v_xor_b32 v1, 192, v2
    ds_write_b128 v1, v[136:139] offset:0
    v_xor_b32 v1, 224, v2
    ds_write_b128 v1, v[140:143] offset:0
    v_xor_b32 v1, 0, v2
    ds_write_b128 v1, v[112:115] offset:16384
    v_xor_b32 v1, 32, v2
    ds_write_b128 v1, v[116:119] offset:16384
    v_xor_b32 v1, 64, v2
    ds_write_b128 v1, v[120:123] offset:16384
    v_xor_b32 v1, 96, v2
    ds_write_b128 v1, v[124:127] offset:16384
    v_xor_b32 v1, 128, v2
    ds_write_b128 v1, v[144:147] offset:16384
    v_xor_b32 v1, 160, v2
    ds_write_b128 v1, v[148:151] offset:16384
    v_xor_b32 v1, 192, v2
    ds_write_b128 v1, v[152:155] offset:16384
    v_xor_b32 v1, 224, v2
    ds_write_b128 v1, v[156:159] offset:16384
    s_waitcnt lgkmcnt(0)
    s_barrier
    s_mov_b32 s39, 0
    s_mul_i32 s43, s26, 4
    v_mov_b32 v44, 0x3d372713
    v_mov_b32 v45, 0x3d372713
    v_mov_b32 v46, 0xc0135761
    v_mov_b32 v47, 0xc0135761
    s_mov_b32 s31, 8
EPL_gemm4_kernel_16:
    v_xor_b32 v1, 16, v5
    ds_read_b128 v[24:27], v5
    ds_read_b128 v[28:31], v1
    s_waitcnt lgkmcnt(0)
    v_cvt_pk_bf16_f32 v40, v24, v25
    v_lshlrev_b32 v24, 16, v40
    v_and_b32 v25, 0xffff0000, v40
    v_pk_mul_f32 v[40:41], v[24:25], v[24:25]
    v_pk_fma_f32 v[40:41], v[40:41], v[44:45], 1.0 op_sel_hi:[1,1,0]
    v_pk_mul_f32 v[40:41], v[40:41], v[24:25]
    v_pk_mul_f32 v[40:41], v[40:41], v[46:47]
    v_exp_f32 v40, v40
    v_exp_f32 v41, v41
    s_nop 0
    v_pk_add_f32 v[40:41], v[40:41], 1.0 op_sel_hi:[1,0]
    v_rcp_f32 v40, v40
    v_rcp_f32 v41, v41
    s_nop 0
    v_pk_mul_f32 v[24:25], v[24:25], v[40:41]
    v_cvt_pk_bf16_f32 v48, v24, v25
    v_cvt_pk_bf16_f32 v40, v26, v27
    v_lshlrev_b32 v26, 16, v40
    v_and_b32 v27, 0xffff0000, v40
    v_pk_mul_f32 v[40:41], v[26:27], v[26:27]
    v_pk_fma_f32 v[40:41], v[40:41], v[44:45], 1.0 op_sel_hi:[1,1,0]
    v_pk_mul_f32 v[40:41], v[40:41], v[26:27]
    v_pk_mul_f32 v[40:41], v[40:41], v[46:47]
    v_exp_f32 v40, v40
    v_exp_f32 v41, v41
    s_nop 0
    v_pk_add_f32 v[40:41], v[40:41], 1.0 op_sel_hi:[1,0]
    v_rcp_f32 v40, v40
    v_rcp_f32 v41, v41
    s_nop 0
    v_pk_mul_f32 v[26:27], v[26:27], v[40:41]
    v_cvt_pk_bf16_f32 v49, v26, v27
    v_cvt_pk_bf16_f32 v40, v28, v29
    v_lshlrev_b32 v28, 16, v40
    v_and_b32 v29, 0xffff0000, v40
    v_pk_mul_f32 v[40:41], v[28:29], v[28:29]
    v_pk_fma_f32 v[40:41], v[40:41], v[44:45], 1.0 op_sel_hi:[1,1,0]
    v_pk_mul_f32 v[40:41], v[40:41], v[28:29]
    v_pk_mul_f32 v[40:41], v[40:41], v[46:47]
    v_exp_f32 v40, v40
    v_exp_f32 v41, v41
    s_nop 0
    v_pk_add_f32 v[40:41], v[40:41], 1.0 op_sel_hi:[1,0]
    v_rcp_f32 v40, v40
    v_rcp_f32 v41, v41
    s_nop 0
    v_pk_mul_f32 v[28:29], v[28:29], v[40:41]
    v_cvt_pk_bf16_f32 v50, v28, v29
    v_cvt_pk_bf16_f32 v40, v30, v31
    v_lshlrev_b32 v30, 16, v40
    v_and_b32 v31, 0xffff0000, v40
    v_pk_mul_f32 v[40:41], v[30:31], v[30:31]
    v_pk_fma_f32 v[40:41], v[40:41], v[44:45], 1.0 op_sel_hi:[1,1,0]
    v_pk_mul_f32 v[40:41], v[40:41], v[30:31]
    v_pk_mul_f32 v[40:41], v[40:41], v[46:47]
    v_exp_f32 v40, v40
    v_exp_f32 v41, v41
    s_nop 0
    v_pk_add_f32 v[40:41], v[40:41], 1.0 op_sel_hi:[1,0]
    v_rcp_f32 v40, v40
    v_rcp_f32 v41, v41
    s_nop 0
    v_pk_mul_f32 v[30:31], v[30:31], v[40:41]
    v_cvt_pk_bf16_f32 v51, v30, v31
    buffer_store_dwordx4 v[48:51], v6, s[12:15], s39 offen
    v_add_u32 v5, 2048, v5
    v_xor_b32 v5, 64, v5
    s_add_u32 s39, s39, s43
    s_sub_u32 s31, s31, 1
    s_cmp_lg_u32 s31, 0
    s_cbranch_scc1 EPL_gemm4_kernel_16
END_gemm4_kernel_1:
    s_endpgm
BODY2_g4at_kernel_1:
    s_sub_u32 s2, s2, 224
    s_cmp_ge_u32 s2, 32
    s_cbranch_scc1 END_attn_kernel_1
    s_load_dwordx2 s[4:5], s[0:1], 96
    s_load_dwordx2 s[6:7], s[0:1], 16
    v_lshrrev_b32 v1, 6, v0
    s_nop 0
    v_readfirstlane_b32 s12, v1
    s_waitcnt lgkmcnt(0)
    s_add_u32 s16, s4, 0x400000
    s_addc_u32 s17, s5, 0
    s_mov_b32 s18, 0xc00000
    s_mov_b32 s19, 0x00020000
    s_add_u32 s20, s6, 0x0
    s_addc_u32 s21, s7, 0
    s_mov_b32 s22, 0x10000
    s_mov_b32 s23, 0x00020000
    s_add_u32 s24, s4, 0x3000000
    s_addc_u32 s25, s5, 0
    s_mov_b32 s26, 0x210000
    s_mov_b32 s27, 0x00020000
    s_add_u32 s36, s4, 0x2c00000
    s_addc_u32 s37, s5, 0
    s_mov_b32 s38, 0x400000
    s_mov_b32 s39, 0x00020000
    s_mov_b32 s13, s2
    v_and_b32 v1, 63, v0
    v_and_b32 v2, 31, v0
    v_bfe_u32 v3, v0, 5, 1
    v_xor_b32 v4, 32, v1
    v_lshlrev_b32 v4, 2, v4
    s_cmp_ge_u32 s12, 4
    s_cbranch_scc1 S1D_attn_kernel_2
    s_mul_i32 s30, s13, 67584
    v_lshlrev_b32 v5, 2, v0
    v_lshlrev_b32 v6, 7, v2
    v_lshrrev_b32 v7, 5, v0
    v_lshl_add_u32 v6, v7, 1, v6
    s_add_u32 s31, s30, 0
    buffer_load_dword v64, v5, s[24:27], s31 offen
    s_add_u32 s31, s30, 8448
    buffer_load_dword v65, v5, s[24:27], s31 offen
    s_add_u32 s31, s30, 16896
    buffer_load_dword v66, v5, s[24:27], s31 offen
    s_add_u32 s31, s30, 25344
    buffer_load_dword v67, v5, s[24:27], s31 offen
    s_add_u32 s31, s30, 33792
    buffer_load_dword v68, v5, s[24:27], s31 offen
    s_add_u32 s31, s30, 42240
    buffer_load_dword v69, v5, s[24:27], s31 offen
    s_add_u32 s31, s30, 50688
    buffer_load_dword v70, v5, s[24:27], s31 offen
    s_add_u32 s31, s30, 59136
    buffer_load_dword v71, v5, s[24:27], s31 offen
    s_add_u32 s31, s30, 1024
    buffer_load_dword v72, v5, s[24:27], s31 offen
    s_add_u32 s31, s30, 9472
    buffer_load_dword v73, v5, s[24:27], s31 offen
    s_add_u32 s31, s30, 17920
    buffer_load_dword v74, v5, s[24:27], s31 offen
    s_add_u32 s31, s30, 26368
    buffer_load_dword v75, v5, s[24:27], s31 offen
    s_add_u32 s31, s30, 34816
    buffer_load_dword v76, v5, s[24:27], s31 offen
    s_add_u32 s31, s30, 43264
    buffer_load_dword v77, v5, s[24:27], s31 offen
    s_add_u32 s31, s30, 51712
    buffer_load_dword v78, v5, s[24:27], s31 offen
    s_add_u32 s31, s30, 60160
    buffer_load_dword v79, v5, s[24:27], s31 offen
    s_add_u32 s31, s30, 2048
    buffer_load_dword v80, v5, s[24:27], s31 offen
    s_add_u32 s31, s30, 10496
    buffer_load_dword v81, v5, s[24:27], s31 offen
    s_add_u32 s31, s30, 18944
    buffer_load_dword v82, v5, s[24:27], s31 offen
    s_add_u32 s31, s30, 27392
    buffer_load_dword v83, v5, s[24:27], s31 offen
    s_add_u32 s31, s30, 35840
    buffer_load_dword v84, v5, s[24:27], s31 offen
    s_add_u32 s31, s30, 44288
    buffer_load_dword v85, v5, s[24:27], s31 offen
    s_add_u32 s31, s30, 52736
    buffer_load_dword v86, v5, s[24:27], s31 offen
    s_add_u32 s31, s30, 61184
    buffer_load_dword v87, v5, s[24:27], s31 offen
    s_add_u32 s31, s30, 3072
    buffer_load_dword v88, v5, s[24:27], s31 offen
    s_add_u32 s31, s30, 11520
    buffer_load_dword v89, v5, s[24:27], s31 offen
    s_add_u32 s31, s30, 19968
    buffer_load_dword v90, v5, s[24:27], s31 offen
    s_add_u32 s31, s30, 28416
    buffer_load_dword v91, v5, s[24:27], s31 offen
    s_add_u32 s31, s30, 36864
    buffer_load_dword v92, v5, s[24:27], s31 offen
    s_add_u32 s31, s30, 45312
    buffer_load_dword v93, v5, s[24:27], s31 offen
    s_add_u32 s31, s30, 53760
    buffer_load_dword v94, v5, s[24:27], s31 offen
    s_add_u32 s31, s30, 62208
    buffer_load_dword v95, v5, s[24:27], s31 offen
    s_add_u32 s31, s30, 4096
    buffer_load_dword v96, v5, s[24:27], s31 offen
    s_add_u32 s31, s30, 12544
    buffer_load_dword v97, v5, s[24:27], s31 offen
    s_add_u32 s31, s30, 20992
    buffer_load_dword v98, v5, s[24:27], s31 offen
    s_add_u32 s31, s30, 29440
    buffer_load_dword v99, v5, s[24:27], s31 offen
    s_add_u32 s31, s30, 37888
    buffer_load_dword v100, v5, s[24:27], s31 offen
    s_add_u32 s31, s30, 46336
    buffer_load_dword v101, v5, s[24:27], s31 offen
    s_add_u32 s31, s30, 54784
    buffer_load_dword v102, v5, s[24:27], s31 offen
    s_add_u32 s31, s30, 63232
    buffer_load_dword v103, v5, s[24:27], s31 offen
    s_add_u32 s31, s30, 5120
    buffer_load_dword v104, v5, s[24:27], s31 offen
    s_add_u32 s31, s30, 13568
    buffer_load_dword v105, v5, s[24:27], s31 offen
    s_add_u32 s31, s30, 22016
    buffer_load_dword v106, v5, s[24:27], s31 offen
    s_add_u32 s31, s30, 30464
    buffer_load_dword v107, v5, s[24:27], s31 offen
    s_add_u32 s31, s30, 38912
    buffer_load_dword v108, v5, s[24:27], s31 offen
    s_add_u32 s31, s30, 47360
    buffer_load_dword v109, v5, s[24:27], s31 offen
    s_add_u32 s31, s30, 55808
    buffer_load_dword v110, v5, s[24:27], s31 offen
    s_add_u32 s31, s30, 64256
    buffer_load_dword v111, v5, s[24:27], s31 offen
    s_add_u32 s31, s30, 6144
    buffer_load_dword v112, v5, s[24:27], s31 offen
    s_add_u32 s31, s30, 14592
    buffer_load_dword v113, v5, s[24:27], s31 offen
    s_add_u32 s31, s30, 23040
    buffer_load_dword v114, v5, s[24:27], s31 offen
    s_add_u32 s31, s30, 31488
    buffer_load_dword v115, v5, s[24:27], s31 offen
    s_add_u32 s31, s30, 39936
    buffer_load_dword v116, v5, s[24:27], s31 offen
    s_add_u32 s31, s30, 48384
    buffer_load_dword v117, v5, s[24:27], s31 offen
    s_add_u32 s31, s30, 56832
    buffer_load_dword v118, v5, s[24:27], s31 offen
    s_add_u32 s31, s30, 65280
    buffer_load_dword v119, v5, s[24:27], s31 offen
    s_add_u32 s31, s30, 7168
    buffer_load_dword v120, v5, s[24:27], s31 offen
    s_add_u32 s31, s30, 15616
    buffer_load_dword v121, v5, s[24:27], s31 offen
    s_add_u32 s31, s30, 24064
    buffer_load_dword v122, v5, s[24:27], s31 offen
    s_add_u32 s31, s30, 32512
    buffer_load_dword v123, v5, s[24:27], s31 offen
    s_add_u32 s31, s30, 40960
    buffer_load_dword v124, v5, s[24:27], s31 offen
    s_add_u32 s31, s30, 49408
    buffer_load_dword v125, v5, s[24:27], s31 offen
    s_add_u32 s31, s30, 57856
    buffer_load_dword v126, v5, s[24:27], s31 offen
    s_add_u32 s31, s30, 66304
    buffer_load_dword v127, v5, s[24:27], s31 offen
    v_cmp_gt_u32 vcc, 64, v0
    s_and_saveexec_b64 s[42:43], vcc
    s_add_u32 s31, s30, 8192
    buffer_load_dword v128, v5, s[24:27], s31 offen
    s_add_u32 s31, s30, 16640
    buffer_load_dword v129, v5, s[24:27], s31 offen
    s_add_u32 s31, s30, 25088
    buffer_load_dword v130, v5, s[24:27], s31 offen
    s_add_u32 s31, s30, 33536
    buffer_load_dword v131, v5, s[24:27], s31 offen
    s_add_u32 s31, s30, 41984
    buffer_load_dword v132, v5, s[24:27], s31 offen
    s_add_u32 s31, s30, 50432
    buffer_load_dword v133, v5, s[24:27], s31 offen
    s_add_u32 s31, s30, 58880
    buffer_load_dword v134, v5, s[24:27], s31 offen
    s_add_u32 s31, s30, 67328
    buffer_load_dword v135, v5, s[24:27], s31 offen
    s_mov_b64 exec, s[42:43]
    s_waitcnt vmcnt(0)
    v_add_f32 v64, v64, v65
    v_add_f32 v64, v64, v66
    v_add_f32 v64, v64, v67
    v_add_f32 v64, v64, v68
    v_add_f32 v64, v64, v69
    v_add_f32 v64, v64, v70
    v_add_f32 v64, v64, v71
    v_cvt_pk_bf16_f32 v64, v64, v64
    ds_write_b16 v6, v64 offset:0
    v_add_f32 v72, v72, v73
    v_add_f32 v72, v72, v74
    v_add_f32 v72, v72, v75
    v_add_f32 v72, v72, v76
    v_add_f32 v72, v72, v77
    v_add_f32 v72, v72, v78
    v_add_f32 v72, v72, v79
    v_cvt_pk_bf16_f32 v72, v72, v72
    ds_write_b16 v6, v72 offset:16
    v_add_f32 v80, v80, v81
    v_add_f32 v80, v80, v82
    v_add_f32 v80, v80, v83
    v_add_f32 v80, v80, v84
    v_add_f32 v80, v80, v85
    v_add_f32 v80, v80, v86
    v_add_f32 v80, v80, v87
    v_cvt_pk_bf16_f32 v80, v80, v80
    ds_write_b16 v6, v80 offset:32
    v_add_f32 v88, v88, v89
    v_add_f32 v88, v88, v90
    v_add_f32 v88, v88, v91
    v_add_f32 v88, v88, v92
    v_add_f32 v88, v88, v93
    v_add_f32 v88, v88, v94
    v_add_f32 v88, v88, v95
    v_cvt_pk_bf16_f32 v88, v88, v88
    ds_write_b16 v6, v88 offset:48
    v_add_f32 v96, v96, v97
    v_add_f32 v96, v96, v98
    v_add_f32 v96, v96, v99
    v_add_f32 v96, v96, v100
    v_add_f32 v96, v96, v101
    v_add_f32 v96, v96, v102
    v_add_f32 v96, v96, v103
    v_cvt_pk_bf16_f32 v96, v96, v96
    ds_write_b16 v6, v96 offset:64
    v_add_f32 v104, v104, v105
    v_add_f32 v104, v104, v106
    v_add_f32 v104, v104, v107
    v_add_f32 v104, v104, v108
    v_add_f32 v104, v104, v109
    v_add_f32 v104, v104, v110
    v_add_f32 v104, v104, v111
    v_cvt_pk_bf16_f32 v104, v104, v104
    ds_write_b16 v6, v104 offset:80
    v_add_f32 v112, v112, v113
    v_add_f32 v112, v112, v114
    v_add_f32 v112, v112, v115
    v_add_f32 v112, v112, v116
    v_add_f32 v112, v112, v117
    v_add_f32 v112, v112, v118
    v_add_f32 v112, v112, v119
    v_cvt_pk_bf16_f32 v112, v112, v112
    ds_write_b16 v6, v112 offset:96
    v_add_f32 v120, v120, v121
    v_add_f32 v120, v120, v122
    v_add_f32 v120, v120, v123
    v_add_f32 v120, v120, v124
    v_add_f32 v120, v120, v125
    v_add_f32 v120, v120, v126
    v_add_f32 v120, v120, v127
    v_cvt_pk_bf16_f32 v120, v120, v120
    ds_write_b16 v6, v120 offset:112
    v_add_f32 v128, v128, v129
    v_add_f32 v128, v128, v130
    v_add_f32 v128, v128, v131
    v_add_f32 v128, v128, v132
    v_add_f32 v128, v128, v133
    v_add_f32 v128, v128, v134
    v_add_f32 v128, v128, v135
    v_cvt_pk_bf16_f32 v128, v128, v128
    v_lshlrev_b32 v6, 1, v0
    v_add_u32 v6, 4096, v6
    s_and_saveexec_b64 s[42:43], vcc
    ds_write_b16 v6, v128
    s_mov_b64 exec, s[42:43]
S1D_attn_kernel_2:
    v_lshlrev_b32 v5, 9, v3
    v_lshl_add_u32 v5, v2, 1, v5
    s_lshl_b32 s40, s13, 11
    buffer_load_ushort v144, v5, s[20:23], s40 offen offset:0
    buffer_load_ushort v145, v5, s[20:23], s40 offen offset:64
    buffer_load_ushort v146, v5, s[20:23], s40 offen offset:128
    buffer_load_ushort v147, v5, s[20:23], s40 offen offset:192
    buffer_load_ushort v148, v5, s[20:23], s40 offen offset:256
    buffer_load_ushort v149, v5, s[20:23], s40 offen offset:320
    buffer_load_ushort v150, v5, s[20:23], s40 offen offset:384
    buffer_load_ushort v151, v5, s[20:23], s40 offen offset:448
    buffer_load_ushort v152, v5, s[20:23], s40 offen offset:1024
    buffer_load_ushort v153, v5, s[20:23], s40 offen offset:1088
    buffer_load_ushort v154, v5, s[20:23], s40 offen offset:1152
    buffer_load_ushort v155, v5, s[20:23], s40 offen offset:1216
    buffer_load_ushort v156, v5, s[20:23], s40 offen offset:1280
    buffer_load_ushort v157, v5, s[20:23], s40 offen offset:1344
    buffer_load_ushort v158, v5, s[20:23], s40 offen offset:1408
    buffer_load_ushort v159, v5, s[20:23], s40 offen offset:1472
    s_waitcnt vmcnt(0)
    v_lshl_or_b32 v8, v145, 16, v144
    v_lshl_or_b32 v9, v147, 16, v146
    v_lshl_or_b32 v10, v149, 16, v148
    v_lshl_or_b32 v11, v151, 16, v150
    v_lshl_or_b32 v12, v153, 16, v152
    v_lshl_or_b32 v13, v155, 16, v154
    v_lshl_or_b32 v14, v157, 16, v156
    v_lshl_or_b32 v15, v159, 16, v158
    s_waitcnt lgkmcnt(0)
    s_barrier
    v_lshlrev_b32 v5, 7, v2
    v_lshl_add_u32 v5, v3, 3, v5
    v_lshlrev_b32 v6, 3, v3
    v_add_u32 v6, 4096, v6
    s_mov_b32 s44, s12
    v_mul_u32_u24 v19, 6144, v2
    v_lshl_add_u32 v19, v3, 4, v19
    s_lshl_b32 s32, s13, 6
    s_mul_i32 s45, s44, 196608
    s_add_u32 s45, s45, s32
    buffer_load_dwordx4 v[184:187], v19, s[16:19], s45 offen
    buffer_load_dwordx4 v[188:191], v19, s[16:19], s45 offen offset:32
TL_attn_kernel_3:
    s_lshl_b32 s30, s44, 5
    s_waitcnt vmcnt(0)
    v_mov_b32 v24, v184
    v_mov_b32 v25, v185
    v_mov_b32 v26, v186
    v_mov_b32 v27, v187
    v_mov_b32 v28, v188
    v_mov_b32 v29, v189
    v_mov_b32 v30, v190
    v_mov_b32 v31, v191
    s_add_u32 s45, s45, 1572864
    buffer_load_dwordx4 v[184:187], v19, s[16:19], s45 offen
    buffer_load_dwordx4 v[188:191], v19, s[16:19], s45 offen offset:32
    v_mov_b32 v128, 0
    v_mov_b32 v129, 0
    v_mov_b32 v130, 0
    v_mov_b32 v131, 0
    v_mov_b32 v132, 0
    v_mov_b32 v133, 0
    v_mov_b32 v134, 0
    v_mov_b32 v135, 0
    v_mov_b32 v136, 0
    v_mov_b32 v137, 0
    v_mov_b32 v138, 0
    v_mov_b32 v139, 0
    v_mov_b32 v140, 0
    v_mov_b32 v141, 0
    v_mov_b32 v142, 0
    v_mov_b32 v143, 0
    v_mov_b32 v64, 0
    v_mov_b32 v65, 0
    v_mov_b32 v66, 0
    v_mov_b32 v67, 0
    v_mov_b32 v68, 0
    v_mov_b32 v69, 0
    v_mov_b32 v70, 0
    v_mov_b32 v71, 0
    v_mov_b32 v72, 0
    v_mov_b32 v73, 0
    v_mov_b32 v74, 0
    v_mov_b32 v75, 0
    v_mov_b32 v76, 0
    v_mov_b32 v77, 0
    v_mov_b32 v78, 0
    v_mov_b32 v79, 0
    v_mov_b32 v80, 0
    v_mov_b32 v81, 0
    v_mov_b32 v82, 0
    v_mov_b32 v83, 0
    v_mov_b32 v84, 0
    v_mov_b32 v85, 0
    v_mov_b32 v86, 0
    v_mov_b32 v87, 0
    v_mov_b32 v88, 0
    v_mov_b32 v89, 0
    v_mov_b32 v90, 0
    v_mov_b32 v91, 0
    v_mov_b32 v92, 0
    v_mov_b32 v93, 0
    v_mov_b32 v94, 0
    v_mov_b32 v95, 0
    v_mfma_f32_32x32x16_bf16 v[128:143], v[8:11], v[24:27], v[128:143]
    v_mfma_f32_32x32x16_bf16 v[128:143], v[12:15], v[28:31], v[128:143]
    s_nop 15
    s_nop 3
    v_cvt_pk_bf16_f32 v146, v128, v129
    v_lshlrev_b32 v128, 16, v146
    v_and_b32 v129, 0xffff0000, v146
    v_cvt_pk_bf16_f32 v146, v130, v131
    v_lshlrev_b32 v130, 16, v146
    v_and_b32 v131, 0xffff0000, v146
    v_cvt_pk_bf16_f32 v146, v132, v133
    v_lshlrev_b32 v132, 16, v146
    v_and_b32 v133, 0xffff0000, v146
    v_cvt_pk_bf16_f32 v146, v134, v135
    v_lshlrev_b32 v134, 16, v146
    v_and_b32 v135, 0xffff0000, v146
    v_cvt_pk_bf16_f32 v146, v136, v137
    v_lshlrev_b32 v136, 16, v146
    v_and_b32 v137, 0xffff0000, v146
    v_cvt_pk_bf16_f32 v146, v138, v139
    v_lshlrev_b32 v138, 16, v146
    v_and_b32 v139, 0xffff0000, v146
    v_cvt_pk_bf16_f32 v146, v140, v141
    v_lshlrev_b32 v140, 16, v146
    v_and_b32 v141, 0xffff0000, v146
    v_cvt_pk_bf16_f32 v146, v142, v143
    v_lshlrev_b32 v142, 16, v146
    v_and_b32 v143, 0xffff0000, v146
    v_max_f32 v144, v128, v129
    v_min_f32 v145, v128, v129
    v_max3_f32 v144, v144, v130, v131
    v_min3_f32 v145, v145, v130, v131
    v_max3_f32 v144, v144, v132, v133
    v_min3_f32 v145, v145, v132, v133
    v_max3_f32 v144, v144, v134, v135
    v_min3_f32 v145, v145, v134, v135
    v_max3_f32 v144, v144, v136, v137
    v_min3_f32 v145, v145, v136, v137
    v_max3_f32 v144, v144, v138, v139
    v_min3_f32 v145, v145, v138, v139
    v_max3_f32 v144, v144, v140, v141
    v_min3_f32 v145, v145, v140, v141
    v_max3_f32 v144, v144, v142, v143
    v_min3_f32 v145, v145, v142, v143
    ds_bpermute_b32 v146, v4, v144
    ds_bpermute_b32 v147, v4, v145
    s_waitcnt lgkmcnt(0)
    v_max_f32 v144, v144, v146
    v_min_f32 v145, v145, v147
    v_mul_f32 v144, 0xbfb8aa3b, v144
    v_mul_f32 v145, 0x3fb8aa3b, v145
    v_mov_b32 v146, 0x3fb8aa3b
    v_fma_f32 v150, v128, v146, v144
    v_fma_f32 v166, -v128, v146, v145
    v_exp_f32 v150, v150
    v_exp_f32 v166, v166
    v_fma_f32 v151, v129, v146, v144
    v_fma_f32 v167, -v129, v146, v145
    v_exp_f32 v151, v151
    v_exp_f32 v167, v167
    v_fma_f32 v152, v130, v146, v144
    v_fma_f32 v168, -v130, v146, v145
    v_exp_f32 v152, v152
    v_exp_f32 v168, v168
    v_fma_f32 v153, v131, v146, v144
    v_fma_f32 v169, -v131, v146, v145
    v_exp_f32 v153, v153
    v_exp_f32 v169, v169
    v_fma_f32 v154, v132, v146, v144
    v_fma_f32 v170, -v132, v146, v145
    v_exp_f32 v154, v154
    v_exp_f32 v170, v170
    v_fma_f32 v155, v133, v146, v144
    v_fma_f32 v171, -v133, v146, v145
    v_exp_f32 v155, v155
    v_exp_f32 v171, v171
    v_fma_f32 v156, v134, v146, v144
    v_fma_f32 v172, -v134, v146, v145
    v_exp_f32 v156, v156
    v_exp_f32 v172, v172
    v_fma_f32 v157, v135, v146, v144
    v_fma_f32 v173, -v135, v146, v145
    v_exp_f32 v157, v157
    v_exp_f32 v173, v173
    v_fma_f32 v158, v136, v146, v144
    v_fma_f32 v174, -v136, v146, v145
    v_exp_f32 v158, v158
    v_exp_f32 v174, v174
    v_fma_f32 v159, v137, v146, v144
    v_fma_f32 v175, -v137, v146, v145
    v_exp_f32 v159, v159
    v_exp_f32 v175, v175
    v_fma_f32 v160, v138, v146, v144
    v_fma_f32 v176, -v138, v146, v145
    v_exp_f32 v160, v160
    v_exp_f32 v176, v176
    v_fma_f32 v161, v139, v146, v144
    v_fma_f32 v177, -v139, v146, v145
    v_exp_f32 v161, v161
    v_exp_f32 v177, v177
    v_fma_f32 v162, v140, v146, v144
    v_fma_f32 v178, -v140, v146, v145
    v_exp_f32 v162, v162
    v_exp_f32 v178, v178
    v_fma_f32 v163, v141, v146, v144
    v_fma_f32 v179, -v141, v146, v145
    v_exp_f32 v163, v163
    v_exp_f32 v179, v179
    v_fma_f32 v164, v142, v146, v144
    v_fma_f32 v180, -v142, v146, v145
    v_exp_f32 v164, v164
    v_exp_f32 v180, v180
    v_fma_f32 v165, v143, v146, v144
    v_fma_f32 v181, -v143, v146, v145
    v_exp_f32 v165, v165
    v_exp_f32 v181, v181
    s_nop 0
    v_add_f32 v148, v150, v151
    v_add_f32 v149, v166, v167
    v_add_f32 v148, v148, v152
    v_add_f32 v149, v149, v168
    v_add_f32 v148, v148, v153
    v_add_f32 v149, v149, v169
    v_add_f32 v148, v148, v154
    v_add_f32 v149, v149, v170
    v_add_f32 v148, v148, v155
    v_add_f32 v149, v149, v171
    v_add_f32 v148, v148, v156
    v_add_f32 v149, v149, v172
    v_add_f32 v148, v148, v157
    v_add_f32 v149, v149, v173
    v_add_f32 v148, v148, v158
    v_add_f32 v149, v149, v174
    v_add_f32 v148, v148, v159
    v_add_f32 v149, v149, v175
    v_add_f32 v148, v148, v160
    v_add_f32 v149, v149, v176
    v_add_f32 v148, v148, v161
    v_add_f32 v149, v149, v177
    v_add_f32 v148, v148, v162
    v_add_f32 v149, v149, v178
    v_add_f32 v148, v148, v163
    v_add_f32 v149, v149, v179
    v_add_f32 v148, v148, v164
    v_add_f32 v149, v149, v180
    v_add_f32 v148, v148, v165
    v_add_f32 v149, v149, v181
    ds_bpermute_b32 v146, v4, v148
    ds_bpermute_b32 v147, v4, v149
    s_waitcnt lgkmcnt(0)
    v_add_f32 v148, v148, v146
    v_add_f32 v149, v149, v147
    v_rcp_f32 v148, v148
    v_rcp_f32 v149, v149
    s_nop 0
    v_mul_f32 v150, v150, v148
    v_mul_f32 v151, v151, v148
    v_cvt_pk_bf16_f32 v40, v150, v151
    v_mul_f32 v166, v166, v149
    v_mul_f32 v167, v167, v149
    v_cvt_pk_bf16_f32 v48, v166, v167
    v_mul_f32 v152, v152, v148
    v_mul_f32 v153, v153, v148
    v_cvt_pk_bf16_f32 v41, v152, v153
    v_mul_f32 v168, v168, v149
    v_mul_f32 v169, v169, v149
    v_cvt_pk_bf16_f32 v49, v168, v169
    v_mul_f32 v154, v154, v148
    v_mul_f32 v155, v155, v148
    v_cvt_pk_bf16_f32 v42, v154, v155
    v_mul_f32 v170, v170, v149
    v_mul_f32 v171, v171, v149
    v_cvt_pk_bf16_f32 v50, v170, v171
    v_mul_f32 v156, v156, v148
    v_mul_f32 v157, v157, v148
    v_cvt_pk_bf16_f32 v43, v156, v157
    v_mul_f32 v172, v172, v149
    v_mul_f32 v173, v173, v149
    v_cvt_pk_bf16_f32 v51, v172, v173
    v_mul_f32 v158, v158, v148
    v_mul_f32 v159, v159, v148
    v_cvt_pk_bf16_f32 v44, v158, v159
    v_mul_f32 v174, v174, v149
    v_mul_f32 v175, v175, v149
    v_cvt_pk_bf16_f32 v52, v174, v175
    v_mul_f32 v160, v160, v148
    v_mul_f32 v161, v161, v148
    v_cvt_pk_bf16_f32 v45, v160, v161
    v_mul_f32 v176, v176, v149
    v_mul_f32 v177, v177, v149
    v_cvt_pk_bf16_f32 v53, v176, v177
    v_mul_f32 v162, v162, v148
    v_mul_f32 v163, v163, v148
    v_cvt_pk_bf16_f32 v46, v162, v163
    v_mul_f32 v178, v178, v149
    v_mul_f32 v179, v179, v149
    v_cvt_pk_bf16_f32 v54, v178, v179
    v_mul_f32 v164, v164, v148
    v_mul_f32 v165, v165, v148
    v_cvt_pk_bf16_f32 v47, v164, v165
    v_mul_f32 v180, v180, v149
    v_mul_f32 v181, v181, v149
    v_cvt_pk_bf16_f32 v55, v180, v181
    ds_read_b64 v[56:57], v5 offset:0
    ds_read_b64 v[58:59], v5 offset:16
    ds_read_b64 v[60:61], v6 offset:0
    ds_read_b64 v[62:63], v6 offset:16
    s_waitcnt lgkmcnt(0)
    v_mfma_f32_32x32x16_bf16 v[64:79], v[56:59], v[40:43], v[64:79]
    v_mfma_f32_32x32x16_bf16 v[80:95], v[60:63], v[40:43], v[80:95]
    s_nop 7
    ds_read_b64 v[56:57], v5 offset:32
    ds_read_b64 v[58:59], v5 offset:48
    ds_read_b64 v[60:61], v6 offset:32
    ds_read_b64 v[62:63], v6 offset:48
    s_waitcnt lgkmcnt(0)
    v_mfma_f32_32x32x16_bf16 v[64:79], v[56:59], v[44:47], v[64:79]
    v_mfma_f32_32x32x16_bf16 v[80:95], v[60:63], v[44:47], v[80:95]
    s_nop 7
    ds_read_b64 v[56:57], v5 offset:64
    ds_read_b64 v[58:59], v5 offset:80
    ds_read_b64 v[60:61], v6 offset:64
    ds_read_b64 v[62:63], v6 offset:80
    s_waitcnt lgkmcnt(0)
    v_mfma_f32_32x32x16_bf16 v[64:79], v[56:59], v[48:51], v[64:79]
    v_mfma_f32_32x32x16_bf16 v[80:95], v[60:63], v[48:51], v[80:95]
    s_nop 7
    ds_read_b64 v[56:57], v5 offset:96
    ds_read_b64 v[58:59], v5 offset:112
    ds_read_b64 v[60:61], v6 offset:96
    ds_read_b64 v[62:63], v6 offset:112
    s_waitcnt lgkmcnt(0)
    v_mfma_f32_32x32x16_bf16 v[64:79], v[56:59], v[52:55], v[64:79]
    v_mfma_f32_32x32x16_bf16 v[80:95], v[60:63], v[52:55], v[80:95]
    s_nop 7
    s_nop 15
    s_nop 3
    v_cvt_pk_bf16_f32 v80, v80, v80
    v_lshlrev_b32 v80, 16, v80
    v_add_f32 v80, 0x358637bd, v80
    v_cvt_pk_bf16_f32 v80, v80, v80
    v_lshlrev_b32 v80, 16, v80
    v_rcp_f32 v81, v80
    s_nop 0
    v_lshlrev_b32 v18, 11, v2
    v_lshl_add_u32 v18, v3, 3, v18
    s_lshl_b32 s31, s30, 11
    s_add_u32 s31, s31, s32
    v_cvt_pk_bf16_f32 v64, v64, v64
    v_lshlrev_b32 v64, 16, v64
    v_mul_f32 v16, v64, v81
    v_fma_f32 v17, -v16, v80, v64
    v_fma_f32 v64, v17, v81, v16
    v_cvt_pk_bf16_f32 v65, v65, v65
    v_lshlrev_b32 v65, 16, v65
    v_mul_f32 v16, v65, v81
    v_fma_f32 v17, -v16, v80, v65
    v_fma_f32 v65, v17, v81, v16
    v_cvt_pk_bf16_f32 v66, v66, v66
    v_lshlrev_b32 v66, 16, v66
    v_mul_f32 v16, v66, v81
    v_fma_f32 v17, -v16, v80, v66
    v_fma_f32 v66, v17, v81, v16
    v_cvt_pk_bf16_f32 v67, v67, v67
    v_lshlrev_b32 v67, 16, v67
    v_mul_f32 v16, v67, v81
    v_fma_f32 v17, -v16, v80, v67
    v_fma_f32 v67, v17, v81, v16
    v_cvt_pk_bf16_f32 v16, v64, v65
    v_cvt_pk_bf16_f32 v17, v66, v67
    buffer_store_dwordx2 v[16:17], v18, s[36:39], s31 offen offset:0
    s_nop 1
    v_cvt_pk_bf16_f32 v68, v68, v68
    v_lshlrev_b32 v68, 16, v68
    v_mul_f32 v16, v68, v81
    v_fma_f32 v17, -v16, v80, v68
    v_fma_f32 v68, v17, v81, v16
    v_cvt_pk_bf16_f32 v69, v69, v69
    v_lshlrev_b32 v69, 16, v69
    v_mul_f32 v16, v69, v81
    v_fma_f32 v17, -v16, v80, v69
    v_fma_f32 v69, v17, v81, v16
    v_cvt_pk_bf16_f32 v70, v70, v70
    v_lshlrev_b32 v70, 16, v70
    v_mul_f32 v16, v70, v81
    v_fma_f32 v17, -v16, v80, v70
    v_fma_f32 v70, v17, v81, v16
    v_cvt_pk_bf16_f32 v71, v71, v71
    v_lshlrev_b32 v71, 16, v71
    v_mul_f32 v16, v71, v81
    v_fma_f32 v17, -v16, v80, v71
    v_fma_f32 v71, v17, v81, v16
    v_cvt_pk_bf16_f32 v16, v68, v69
    v_cvt_pk_bf16_f32 v17, v70, v71
    buffer_store_dwordx2 v[16:17], v18, s[36:39], s31 offen offset:16
    s_nop 1
    v_cvt_pk_bf16_f32 v72, v72, v72
    v_lshlrev_b32 v72, 16, v72
    v_mul_f32 v16, v72, v81
    v_fma_f32 v17, -v16, v80, v72
    v_fma_f32 v72, v17, v81, v16
    v_cvt_pk_bf16_f32 v73, v73, v73
    v_lshlrev_b32 v73, 16, v73
    v_mul_f32 v16, v73, v81
    v_fma_f32 v17, -v16, v80, v73
    v_fma_f32 v73, v17, v81, v16
    v_cvt_pk_bf16_f32 v74, v74, v74
    v_lshlrev_b32 v74, 16, v74
    v_mul_f32 v16, v74, v81
    v_fma_f32 v17, -v16, v80, v74
    v_fma_f32 v74, v17, v81, v16
    v_cvt_pk_bf16_f32 v75, v75, v75
    v_lshlrev_b32 v75, 16, v75
    v_mul_f32 v16, v75, v81
    v_fma_f32 v17, -v16, v80, v75
    v_fma_f32 v75, v17, v81, v16
    v_cvt_pk_bf16_f32 v16, v72, v73
    v_cvt_pk_bf16_f32 v17, v74, v75
    buffer_store_dwordx2 v[16:17], v18, s[36:39], s31 offen offset:32
    s_nop 1
    v_cvt_pk_bf16_f32 v76, v76, v76
    v_lshlrev_b32 v76, 16, v76
    v_mul_f32 v16, v76, v81
    v_fma_f32 v17, -v16, v80, v76
    v_fma_f32 v76, v17, v81, v16
    v_cvt_pk_bf16_f32 v77, v77, v77
    v_lshlrev_b32 v77, 16, v77
    v_mul_f32 v16, v77, v81
    v_fma_f32 v17, -v16, v80, v77
    v_fma_f32 v77, v17, v81, v16
    v_cvt_pk_bf16_f32 v78, v78, v78
    v_lshlrev_b32 v78, 16, v78
    v_mul_f32 v16, v78, v81
    v_fma_f32 v17, -v16, v80, v78
    v_fma_f32 v78, v17, v81, v16
    v_cvt_pk_bf16_f32 v79, v79, v79
    v_lshlrev_b32 v79, 16, v79
    v_mul_f32 v16, v79, v81
    v_fma_f32 v17, -v16, v80, v79
    v_fma_f32 v79, v17, v81, v16
    v_cvt_pk_bf16_f32 v16, v76, v77
    v_cvt_pk_bf16_f32 v17, v78, v79
    buffer_store_dwordx2 v[16:17], v18, s[36:39], s31 offen offset:48
    s_nop 1
    s_add_u32 s44, s44, 8
    s_cmp_lt_u32 s44, 64
    s_cbranch_scc1 TL_attn_kernel_3
END_attn_kernel_1:
    s_endpgm
.globl gemm5_kernel
.p2align 8
.type gemm5_kernel,@function
gemm5_kernel:
    s_cmp_ge_u32 s2, 256
    s_cbranch_scc1 END_gemm5_kernel_1
    v_lshrrev_b32 v1, 6, v0
    s_nop 0
    v_readfirstlane_b32 s30, v1
    s_load_dwordx2 s[44:45], s[0:1], 24
    s_load_dwordx2 s[46:47], s[0:1], 64
    s_load_dwordx2 s[48:49], s[0:1], 96
    s_load_dwordx2 s[50:51], s[0:1], 80
    s_waitcnt lgkmcnt(0)
    s_add_u32 s12, s50, 0x0
    s_addc_u32 s13, s51, 0
    s_mov_b32 s14, 0x400000
    s_mov_b32 s15, 0x00020000
    s_add_u32 s16, s48, 0x1400000
    s_addc_u32 s17, s49, 0
    s_mov_b32 s18, 0x400000
    s_mov_b32 s19, 0x00020000
    s_add_u32 s20, s48, 0x3400000
    s_addc_u32 s21, s49, 0
    s_mov_b32 s22, 0x2000
    s_mov_b32 s23, 0x00020000
    s_add_u32 s52, s48, 0x3800000
    s_addc_u32 s53, s49, 0
    s_mov_b32 s54, 0x800000
    s_mov_b32 s55, 0x00020000
    s_add_u32 s56, s48, 0x3500000
    s_addc_u32 s57, s49, 0
    s_mov_b32 s58, 0x400
    s_mov_b32 s59, 0x00020000
    s_mov_b32 s25, 2048
    s_mov_b32 s26, 2048
    s_bfe_u32 s41, s2, 0x10003
    s_lshr_b32 s60, s2, 4
    s_lshl_b32 s60, s60, 3
    s_and_b32 s61, s2, 7
    s_add_u32 s60, s60, s61
    s_and_b32 s28, s60, 15
    s_lshl_b32 s28, s28, 7
    s_lshr_b32 s29, s60, 4
    s_lshl_b32 s29, s29, 7
    s_cmp_eq_u32 s41, 1
    s_cbranch_scc1 HALF1_gemm5_kernel_2
    s_add_u32 s4, s48, 0x2c00000
    s_addc_u32 s5, s49, 0
    s_mov_b32 s6, 0x400000
    s_mov_b32 s7, 0x00020000
    s_add_u32 s8, s44, 0x0
    s_addc_u32 s9, s45, 0
    s_mov_b32 s10, 0x200000
    s_mov_b32 s11, 0x00020000
    s_mov_b32 s24, 2048
    s_mov_b32 s27, 16
    v_and_b32 v1, 63, v0
    v_lshrrev_b32 v2, 3, v1
    s_mul_i32 s38, s30, 16
    v_add_u32 v2, s38, v2
    v_mul_lo_u32 v2, v2, s24
    v_and_b32 v3, 7, v1
    v_lshrrev_b32 v4, 4, v1
    v_xor_b32 v3, v3, v4
    s_mul_i32 s38, s30, 2
    s_add_u32 s38, s38, 0
    s_and_b32 s38, s38, 1
    s_lshl_b32 s38, s38, 2
    v_xor_b32 v4, s38, v3
    v_lshl_add_u32 v15, v4, 4, v2
    s_lshl_b32 s38, s24, 3
    v_add_u32 v2, s38, v2
    s_mul_i32 s38, s30, 2
    s_add_u32 s38, s38, 1
    s_and_b32 s38, s38, 1
    s_lshl_b32 s38, s38, 2
    v_xor_b32 v4, s38, v3
    v_lshl_add_u32 v16, v4, 4, v2
    v_lshrrev_b32 v2, 4, v1
    s_mul_i32 s38, s30, 8
    v_add_u32 v3, s38, v2
    v_mul_lo_u32 v3, v3, s25
    v_lshlrev_b32 v2, 2, v2
    v_and_b32 v4, 15, v1
    v_xor_b32 v4, v4, v2
    v_lshl_add_u32 v17, v4, 4, v3
    s_lshl_b32 s38, s25, 2
    v_add_u32 v3, s38, v3
    v_lshl_add_u32 v18, v4, 4, v3
    s_mul_i32 s36, s30, 2048
    s_mul_i32 s37, s30, 2048
    s_add_u32 s37, s37, 16384
    s_and_b32 s42, s30, 1
    s_lshr_b32 s43, s30, 1
    v_and_b32 v2, 31, v1
    s_mul_i32 s38, s42, 64
    v_add_u32 v2, s38, v2
    v_lshlrev_b32 v2, 7, v2
    v_lshrrev_b32 v3, 5, v1
    v_bfe_u32 v4, v1, 1, 3
    v_xor_b32 v3, v3, v4
    v_xor_b32 v4, 0, v3
    v_lshl_add_u32 v10, v4, 4, v2
    v_xor_b32 v4, 2, v3
    v_lshl_add_u32 v11, v4, 4, v2
    v_xor_b32 v4, 4, v3
    v_lshl_add_u32 v12, v4, 4, v2
    v_xor_b32 v4, 6, v3
    v_lshl_add_u32 v13, v4, 4, v2
    v_bfe_u32 v2, v1, 2, 2
    v_lshrrev_b32 v3, 5, v1
    v_lshl_add_u32 v3, v3, 3, v2
    v_mul_u32_u24 v3, 256, v3
    v_bfe_u32 v4, v1, 4, 1
    v_lshl_add_u32 v3, v4, 5, v3
    v_and_b32 v4, 3, v1
    v_lshl_add_u32 v3, v4, 3, v3
    v_add_u32 v3, 16384, v3
    s_mul_i32 s38, s43, 1
    s_add_u32 s38, s38, 0
    v_xor_b32 v4, s38, v2
    v_lshl_add_u32 v14, v4, 6, v3
    s_mul_i32 s32, s28, s24
    s_lshl_b32 s33, s29, 1
    s_lshl_b32 s42, s25, 6
    v_mov_b32 v80, 0
    v_mov_b32 v81, 0
    v_mov_b32 v82, 0
    v_mov_b32 v83, 0
    v_mov_b32 v84, 0
    v_mov_b32 v85, 0
    v_mov_b32 v86, 0
    v_mov_b32 v87, 0
    v_mov_b32 v88, 0
    v_mov_b32 v89, 0
    v_mov_b32 v90, 0
    v_mov_b32 v91, 0
    v_mov_b32 v92, 0
    v_mov_b32 v93, 0
    v_mov_b32 v94, 0
    v_mov_b32 v95, 0
    v_mov_b32 v96, 0
    v_mov_b32 v97, 0
    v_mov_b32 v98, 0
    v_mov_b32 v99, 0
    v_mov_b32 v100, 0
    v_mov_b32 v101, 0
    v_mov_b32 v102, 0
    v_mov_b32 v103, 0
    v_mov_b32 v104, 0
    v_mov_b32 v105, 0
    v_mov_b32 v106, 0
    v_mov_b32 v107, 0
    v_mov_b32 v108, 0
    v_mov_b32 v109, 0
    v_mov_b32 v110, 0
    v_mov_b32 v111, 0
    s_mov_b32 s31, 0
    s_mov_b32 s35, 0
    s_add_u32 m0, s35, s36
    s_nop 0
    buffer_load_dwordx4 v15, s[4:7], s32 offen lds
    s_add_u32 m0, m0, 1024
    s_nop 0
    buffer_load_dwordx4 v16, s[4:7], s32 offen lds
    s_add_u32 m0, s35, s37
    s_nop 0
    buffer_load_dwordx4 v17, s[8:11], s33 offen lds
    s_add_u32 m0, m0, 1024
    s_nop 0
    buffer_load_dwordx4 v18, s[8:11], s33 offen lds
    s_add_u32 s32, s32, 128
    s_add_u32 s33, s33, s42
    s_add_u32 s31, s31, 1
    s_mov_b32 s35, 32768
    s_add_u32 m0, s35, s36
    s_nop 0
    buffer_load_dwordx4 v15, s[4:7], s32 offen lds
    s_add_u32 m0, m0, 1024
    s_nop 0
    buffer_load_dwordx4 v16, s[4:7], s32 offen lds
    s_add_u32 m0, s35, s37
    s_nop 0
    buffer_load_dwordx4 v17, s[8:11], s33 offen lds
    s_add_u32 m0, m0, 1024
    s_nop 0
    buffer_load_dwordx4 v18, s[8:11], s33 offen lds
    s_add_u32 s32, s32, 128
    s_add_u32 s33, s33, s42
    s_add_u32 s31, s31, 1
    s_mov_b32 s35, 65536
    s_add_u32 m0, s35, s36
    s_nop 0
    buffer_load_dwordx4 v15, s[4:7], s32 offen lds
    s_add_u32 m0, m0, 1024
    s_nop 0
    buffer_load_dwordx4 v16, s[4:7], s32 offen lds
    s_add_u32 m0, s35, s37
    s_nop 0
    buffer_load_dwordx4 v17, s[8:11], s33 offen lds
    s_add_u32 m0, m0, 1024
    s_nop 0
    buffer_load_dwordx4 v18, s[8:11], s33 offen lds
    s_add_u32 s32, s32, 128
    s_add_u32 s33, s33, s42
    s_add_u32 s31, s31, 1
    s_mov_b32 s35, 98304
    s_mov_b32 s34, 0
    s_mov_b32 s43, 0
    s_waitcnt vmcnt(8)
    s_barrier
    s_cmp_ge_u32 s30, 4
    s_cbranch_scc1 GRPB_gemm5_kernel_4
PPL_gemm5_kernel_6:
    ds_read_b128 v[20:23], v10 offset:0
    ds_read_b128 v[36:39], v10 offset:4096
    ds_read_b64_tr_b16 v[52:53], v14 offset:0
    ds_read_b64_tr_b16 v[54:55], v14 offset:1024
    ds_read_b128 v[24:27], v11 offset:0
    ds_read_b128 v[40:43], v11 offset:4096
    ds_read_b64_tr_b16 v[56:57], v14 offset:4096
    ds_read_b64_tr_b16 v[58:59], v14 offset:5120
    ds_read_b128 v[28:31], v12 offset:0
    ds_read_b128 v[44:47], v12 offset:4096
    ds_read_b64_tr_b16 v[60:61], v14 offset:8192
    ds_read_b64_tr_b16 v[62:63], v14 offset:9216
    ds_read_b128 v[32:35], v13 offset:0
    ds_read_b128 v[48:51], v13 offset:4096
    ds_read_b64_tr_b16 v[64:65], v14 offset:12288
    ds_read_b64_tr_b16 v[66:67], v14 offset:13312
    s_cmp_ge_u32 s31, s27
    s_cbranch_scc1 PPN_gemm5_kernel_7
    s_add_u32 m0, s35, s36
    s_nop 0
    buffer_load_dwordx4 v15, s[4:7], s32 offen lds
    s_add_u32 m0, m0, 1024
    s_nop 0
    buffer_load_dwordx4 v16, s[4:7], s32 offen lds
    s_add_u32 m0, s35, s37
    s_nop 0
    buffer_load_dwordx4 v17, s[8:11], s33 offen lds
    s_add_u32 m0, m0, 1024
    s_nop 0
    buffer_load_dwordx4 v18, s[8:11], s33 offen lds
    s_add_u32 s32, s32, 128
    s_add_u32 s33, s33, s42
    s_add_u32 s31, s31, 1
PPN_gemm5_kernel_7:
    s_waitcnt lgkmcnt(0)
    s_barrier
    s_setprio 1
    v_mfma_f32_32x32x16_bf16 v[80:95], v[52:55], v[20:23], v[80:95]
    v_mfma_f32_32x32x16_bf16 v[96:111], v[52:55], v[36:39], v[96:111]
    v_mfma_f32_32x32x16_bf16 v[80:95], v[56:59], v[24:27], v[80:95]
    v_mfma_f32_32x32x16_bf16 v[96:111], v[56:59], v[40:43], v[96:111]
    v_mfma_f32_32x32x16_bf16 v[80:95], v[60:63], v[28:31], v[80:95]
    v_mfma_f32_32x32x16_bf16 v[96:111], v[60:63], v[44:47], v[96:111]
    v_mfma_f32_32x32x16_bf16 v[80:95], v[64:67], v[32:35], v[80:95]
    v_mfma_f32_32x32x16_bf16 v[96:111], v[64:67], v[48:51], v[96:111]
    s_setprio 0
    s_mov_b32 s39, s34
    s_add_u32 s34, s34, 32768
    s_cmp_eq_u32 s34, 131072
    s_cselect_b32 s34, 0, s34
    s_sub_u32 s38, s34, s39
    v_add_u32 v10, s38, v10
    v_add_u32 v11, s38, v11
    v_add_u32 v12, s38, v12
    v_add_u32 v13, s38, v13
    v_add_u32 v14, s38, v14
    s_add_u32 s35, s35, 32768
    s_cmp_eq_u32 s35, 131072
    s_cselect_b32 s35, 0, s35
    s_add_u32 s43, s43, 1
    s_add_u32 s38, s43, 3
    s_cmp_eq_u32 s38, s31
    s_cbranch_scc1 PX0_gemm5_kernel_10
    s_waitcnt vmcnt(0)
    s_branch PX1_gemm5_kernel_11
PX0_gemm5_kernel_10:
    s_waitcnt vmcnt(8)
PX1_gemm5_kernel_11:
    s_barrier
    s_cmp_lt_u32 s43, s27
    s_cbranch_scc1 PPL_gemm5_kernel_6
    s_barrier
    s_branch PPD_gemm5_kernel_5
GRPB_gemm5_kernel_4:
    s_barrier
PPL_gemm5_kernel_12:
    ds_read_b128 v[20:23], v10 offset:0
    ds_read_b128 v[36:39], v10 offset:4096
    ds_read_b64_tr_b16 v[52:53], v14 offset:0
    ds_read_b64_tr_b16 v[54:55], v14 offset:1024
    ds_read_b128 v[24:27], v11 offset:0
    ds_read_b128 v[40:43], v11 offset:4096
    ds_read_b64_tr_b16 v[56:57], v14 offset:4096
    ds_read_b64_tr_b16 v[58:59], v14 offset:5120
    ds_read_b128 v[28:31], v12 offset:0
    ds_read_b128 v[44:47], v12 offset:4096
    ds_read_b64_tr_b16 v[60:61], v14 offset:8192
    ds_read_b64_tr_b16 v[62:63], v14 offset:9216
    ds_read_b128 v[32:35], v13 offset:0
    ds_read_b128 v[48:51], v13 offset:4096
    ds_read_b64_tr_b16 v[64:65], v14 offset:12288
    ds_read_b64_tr_b16 v[66:67], v14 offset:13312
    s_cmp_ge_u32 s31, s27
    s_cbranch_scc1 PPN_gemm5_kernel_13
    s_add_u32 m0, s35, s36
    s_nop 0
    buffer_load_dwordx4 v15, s[4:7], s32 offen lds
    s_add_u32 m0, m0, 1024
    s_nop 0
    buffer_load_dwordx4 v16, s[4:7], s32 offen lds
    s_add_u32 m0, s35, s37
    s_nop 0
    buffer_load_dwordx4 v17, s[8:11], s33 offen lds
    s_add_u32 m0, m0, 1024
    s_nop 0
    buffer_load_dwordx4 v18, s[8:11], s33 offen lds
    s_add_u32 s32, s32, 128
    s_add_u32 s33, s33, s42
    s_add_u32 s31, s31, 1
PPN_gemm5_kernel_13:
    s_add_u32 s38, s43, 4
    s_cmp_eq_u32 s38, s31
    s_cbranch_scc1 PW0_gemm5_kernel_14
    s_waitcnt vmcnt(0) lgkmcnt(0)
    s_branch PW1_gemm5_kernel_15
PW0_gemm5_kernel_14:
    s_waitcnt vmcnt(8) lgkmcnt(0)
PW1_gemm5_kernel_15:
    s_barrier
    s_setprio 1
    v_mfma_f32_32x32x16_bf16 v[80:95], v[52:55], v[20:23], v[80:95]
    v_mfma_f32_32x32x16_bf16 v[96:111], v[52:55], v[36:39], v[96:111]
    v_mfma_f32_32x32x16_bf16 v[80:95], v[56:59], v[24:27], v[80:95]
    v_mfma_f32_32x32x16_bf16 v[96:111], v[56:59], v[40:43], v[96:111]
    v_mfma_f32_32x32x16_bf16 v[80:95], v[60:63], v[28:31], v[80:95]
    v_mfma_f32_32x32x16_bf16 v[96:111], v[60:63], v[44:47], v[96:111]
    v_mfma_f32_32x32x16_bf16 v[80:95], v[64:67], v[32:35], v[80:95]
    v_mfma_f32_32x32x16_bf16 v[96:111], v[64:67], v[48:51], v[96:111]
    s_setprio 0
    s_mov_b32 s39, s34
    s_add_u32 s34, s34, 32768
    s_cmp_eq_u32 s34, 131072
    s_cselect_b32 s34, 0, s34
    s_sub_u32 s38, s34, s39
    v_add_u32 v10, s38, v10
    v_add_u32 v11, s38, v11
    v_add_u32 v12, s38, v12
    v_add_u32 v13, s38, v13
    v_add_u32 v14, s38, v14
    s_add_u32 s35, s35, 32768
    s_cmp_eq_u32 s35, 131072
    s_cselect_b32 s35, 0, s35
    s_add_u32 s43, s43, 1
    s_barrier
    s_cmp_lt_u32 s43, s27
    s_cbranch_scc1 PPL_gemm5_kernel_12
PPD_gemm5_kernel_5:
    s_sub_u32 s38, 0, s34
    v_add_u32 v10, s38, v10
    v_add_u32 v11, s38, v11
    v_add_u32 v12, s38, v12
    v_add_u32 v13, s38, v13
    v_add_u32 v14, s38, v14
    s_nop 15
    s_nop 7
    v_mov_b32 v112, v80
    v_mov_b32 v113, v81
    v_mov_b32 v114, v82
    v_mov_b32 v115, v83
    v_mov_b32 v116, v84
    v_mov_b32 v117, v85
    v_mov_b32 v118, v86
    v_mov_b32 v119, v87
    v_mov_b32 v120, v88
    v_mov_b32 v121, v89
    v_mov_b32 v122, v90
    v_mov_b32 v123, v91
    v_mov_b32 v124, v92
    v_mov_b32 v125, v93
    v_mov_b32 v126, v94
    v_mov_b32 v127, v95
    v_mov_b32 v128, v96
    v_mov_b32 v129, v97
    v_mov_b32 v130, v98
    v_mov_b32 v131, v99
    v_mov_b32 v132, v100
    v_mov_b32 v133, v101
    v_mov_b32 v134, v102
    v_mov_b32 v135, v103
    v_mov_b32 v136, v104
    v_mov_b32 v137, v105
    v_mov_b32 v138, v106
    v_mov_b32 v139, v107
    v_mov_b32 v140, v108
    v_mov_b32 v141, v109
    v_mov_b32 v142, v110
    v_mov_b32 v143, v111
    s_add_u32 s4, s48, 0x1c00000
    s_addc_u32 s5, s49, 0
    s_mov_b32 s6, 0xe00000
    s_mov_b32 s7, 0x00020000
    s_add_u32 s8, s46, 0x0
    s_addc_u32 s9, s47, 0
    s_mov_b32 s10, 0x700000
    s_mov_b32 s11, 0x00020000
    s_mov_b32 s24, 7168
    s_mov_b32 s27, 20
    v_and_b32 v1, 63, v0
    v_lshrrev_b32 v2, 3, v1
    s_mul_i32 s38, s30, 16
    v_add_u32 v2, s38, v2
    v_mul_lo_u32 v2, v2, s24
    v_and_b32 v3, 7, v1
    v_lshrrev_b32 v4, 4, v1
    v_xor_b32 v3, v3, v4
    s_mul_i32 s38, s30, 2
    s_add_u32 s38, s38, 0
    s_and_b32 s38, s38, 1
    s_lshl_b32 s38, s38, 2
    v_xor_b32 v4, s38, v3
    v_lshl_add_u32 v15, v4, 4, v2
    s_lshl_b32 s38, s24, 3
    v_add_u32 v2, s38, v2
    s_mul_i32 s38, s30, 2
    s_add_u32 s38, s38, 1
    s_and_b32 s38, s38, 1
    s_lshl_b32 s38, s38, 2
    v_xor_b32 v4, s38, v3
    v_lshl_add_u32 v16, v4, 4, v2
    v_lshrrev_b32 v2, 4, v1
    s_mul_i32 s38, s30, 8
    v_add_u32 v3, s38, v2
    v_mul_lo_u32 v3, v3, s25
    v_lshlrev_b32 v2, 2, v2
    v_and_b32 v4, 15, v1
    v_xor_b32 v4, v4, v2
    v_lshl_add_u32 v17, v4, 4, v3
    s_lshl_b32 s38, s25, 2
    v_add_u32 v3, s38, v3
    v_lshl_add_u32 v18, v4, 4, v3
    s_mul_i32 s36, s30, 2048
    s_mul_i32 s37, s30, 2048
    s_add_u32 s37, s37, 16384
    s_and_b32 s42, s30, 1
    s_lshr_b32 s43, s30, 1
    v_and_b32 v2, 31, v1
    s_mul_i32 s38, s42, 64
    v_add_u32 v2, s38, v2
    v_lshlrev_b32 v2, 7, v2
    v_lshrrev_b32 v3, 5, v1
    v_bfe_u32 v4, v1, 1, 3
    v_xor_b32 v3, v3, v4
    v_xor_b32 v4, 0, v3
    v_lshl_add_u32 v10, v4, 4, v2
    v_xor_b32 v4, 2, v3
    v_lshl_add_u32 v11, v4, 4, v2
    v_xor_b32 v4, 4, v3
    v_lshl_add_u32 v12, v4, 4, v2
    v_xor_b32 v4, 6, v3
    v_lshl_add_u32 v13, v4, 4, v2
    v_bfe_u32 v2, v1, 2, 2
    v_lshrrev_b32 v3, 5, v1
    v_lshl_add_u32 v3, v3, 3, v2
    v_mul_u32_u24 v3, 256, v3
    v_bfe_u32 v4, v1, 4, 1
    v_lshl_add_u32 v3, v4, 5, v3
    v_and_b32 v4, 3, v1
    v_lshl_add_u32 v3, v4, 3, v3
    v_add_u32 v3, 16384, v3
    s_mul_i32 s38, s43, 1
    s_add_u32 s38, s38, 0
    v_xor_b32 v4, s38, v2
    v_lshl_add_u32 v14, v4, 6, v3
    s_mul_i32 s32, s28, s24
    s_lshl_b32 s33, s29, 1
    s_lshl_b32 s42, s25, 6
    v_mov_b32 v80, 0
    v_mov_b32 v81, 0
    v_mov_b32 v82, 0
    v_mov_b32 v83, 0
    v_mov_b32 v84, 0
    v_mov_b32 v85, 0
    v_mov_b32 v86, 0
    v_mov_b32 v87, 0
    v_mov_b32 v88, 0
    v_mov_b32 v89, 0
    v_mov_b32 v90, 0
    v_mov_b32 v91, 0
    v_mov_b32 v92, 0
    v_mov_b32 v93, 0
    v_mov_b32 v94, 0
    v_mov_b32 v95, 0
    v_mov_b32 v96, 0
    v_mov_b32 v97, 0
    v_mov_b32 v98, 0
    v_mov_b32 v99, 0
    v_mov_b32 v100, 0
    v_mov_b32 v101, 0
    v_mov_b32 v102, 0
    v_mov_b32 v103, 0
    v_mov_b32 v104, 0
    v_mov_b32 v105, 0
    v_mov_b32 v106, 0
    v_mov_b32 v107, 0
    v_mov_b32 v108, 0
    v_mov_b32 v109, 0
    v_mov_b32 v110, 0
    v_mov_b32 v111, 0
    s_mov_b32 s31, 0
    s_mov_b32 s35, 0
    s_add_u32 m0, s35, s36
    s_nop 0
    buffer_load_dwordx4 v15, s[4:7], s32 offen lds
    s_add_u32 m0, m0, 1024
    s_nop 0
    buffer_load_dwordx4 v16, s[4:7], s32 offen lds
    s_add_u32 m0, s35, s37
    s_nop 0
    buffer_load_dwordx4 v17, s[8:11], s33 offen lds
    s_add_u32 m0, m0, 1024
    s_nop 0
    buffer_load_dwordx4 v18, s[8:11], s33 offen lds
    s_add_u32 s32, s32, 128
    s_add_u32 s33, s33, s42
    s_add_u32 s31, s31, 1
    s_mov_b32 s35, 32768
    s_add_u32 m0, s35, s36
    s_nop 0
    buffer_load_dwordx4 v15, s[4:7], s32 offen lds
    s_add_u32 m0, m0, 1024
    s_nop 0
    buffer_load_dwordx4 v16, s[4:7], s32 offen lds
    s_add_u32 m0, s35, s37
    s_nop 0
    buffer_load_dwordx4 v17, s[8:11], s33 offen lds
    s_add_u32 m0, m0, 1024
    s_nop 0
    buffer_load_dwordx4 v18, s[8:11], s33 offen lds
    s_add_u32 s32, s32, 128
    s_add_u32 s33, s33, s42
    s_add_u32 s31, s31, 1
    s_mov_b32 s35, 65536
    s_add_u32 m0, s35, s36
    s_nop 0
    buffer_load_dwordx4 v15, s[4:7], s32 offen lds
    s_add_u32 m0, m0, 1024
    s_nop 0
    buffer_load_dwordx4 v16, s[4:7], s32 offen lds
    s_add_u32 m0, s35, s37
    s_nop 0
    buffer_load_dwordx4 v17, s[8:11], s33 offen lds
    s_add_u32 m0, m0, 1024
    s_nop 0
    buffer_load_dwordx4 v18, s[8:11], s33 offen lds
    s_add_u32 s32, s32, 128
    s_add_u32 s33, s33, s42
    s_add_u32 s31, s31, 1
    s_mov_b32 s35, 98304
    s_mov_b32 s34, 0
    s_mov_b32 s43, 0
    s_waitcnt vmcnt(8)
    s_barrier
    s_cmp_ge_u32 s30, 4
    s_cbranch_scc1 GRPB_gemm5_kernel_18
PPL_gemm5_kernel_20:
    ds_read_b128 v[20:23], v10 offset:0
    ds_read_b128 v[36:39], v10 offset:4096
    ds_read_b64_tr_b16 v[52:53], v14 offset:0
    ds_read_b64_tr_b16 v[54:55], v14 offset:1024
    ds_read_b128 v[24:27], v11 offset:0
    ds_read_b128 v[40:43], v11 offset:4096
    ds_read_b64_tr_b16 v[56:57], v14 offset:4096
    ds_read_b64_tr_b16 v[58:59], v14 offset:5120
    ds_read_b128 v[28:31], v12 offset:0
    ds_read_b128 v[44:47], v12 offset:4096
    ds_read_b64_tr_b16 v[60:61], v14 offset:8192
    ds_read_b64_tr_b16 v[62:63], v14 offset:9216
    ds_read_b128 v[32:35], v13 offset:0
    ds_read_b128 v[48:51], v13 offset:4096
    ds_read_b64_tr_b16 v[64:65], v14 offset:12288
    ds_read_b64_tr_b16 v[66:67], v14 offset:13312
    s_cmp_ge_u32 s31, s27
    s_cbranch_scc1 PPN_gemm5_kernel_21
    s_add_u32 m0, s35, s36
    s_nop 0
    buffer_load_dwordx4 v15, s[4:7], s32 offen lds
    s_add_u32 m0, m0, 1024
    s_nop 0
    buffer_load_dwordx4 v16, s[4:7], s32 offen lds
    s_add_u32 m0, s35, s37
    s_nop 0
    buffer_load_dwordx4 v17, s[8:11], s33 offen lds
    s_add_u32 m0, m0, 1024
    s_nop 0
    buffer_load_dwordx4 v18, s[8:11], s33 offen lds
    s_add_u32 s32, s32, 128
    s_add_u32 s33, s33, s42
    s_add_u32 s31, s31, 1
PPN_gemm5_kernel_21:
    s_waitcnt lgkmcnt(0)
    s_barrier
    s_setprio 1
    v_mfma_f32_32x32x16_bf16 v[80:95], v[52:55], v[20:23], v[80:95]
    v_mfma_f32_32x32x16_bf16 v[96:111], v[52:55], v[36:39], v[96:111]
    v_mfma_f32_32x32x16_bf16 v[80:95], v[56:59], v[24:27], v[80:95]
    v_mfma_f32_32x32x16_bf16 v[96:111], v[56:59], v[40:43], v[96:111]
    v_mfma_f32_32x32x16_bf16 v[80:95], v[60:63], v[28:31], v[80:95]
    v_mfma_f32_32x32x16_bf16 v[96:111], v[60:63], v[44:47], v[96:111]
    v_mfma_f32_32x32x16_bf16 v[80:95], v[64:67], v[32:35], v[80:95]
    v_mfma_f32_32x32x16_bf16 v[96:111], v[64:67], v[48:51], v[96:111]
    s_setprio 0
    s_mov_b32 s39, s34
    s_add_u32 s34, s34, 32768
    s_cmp_eq_u32 s34, 131072
    s_cselect_b32 s34, 0, s34
    s_sub_u32 s38, s34, s39
    v_add_u32 v10, s38, v10
    v_add_u32 v11, s38, v11
    v_add_u32 v12, s38, v12
    v_add_u32 v13, s38, v13
    v_add_u32 v14, s38, v14
    s_add_u32 s35, s35, 32768
    s_cmp_eq_u32 s35, 131072
    s_cselect_b32 s35, 0, s35
    s_add_u32 s43, s43, 1
    s_add_u32 s38, s43, 3
    s_cmp_eq_u32 s38, s31
    s_cbranch_scc1 PX0_gemm5_kernel_24
    s_waitcnt vmcnt(0)
    s_branch PX1_gemm5_kernel_25
PX0_gemm5_kernel_24:
    s_waitcnt vmcnt(8)
PX1_gemm5_kernel_25:
    s_barrier
    s_cmp_lt_u32 s43, s27
    s_cbranch_scc1 PPL_gemm5_kernel_20
    s_barrier
    s_branch PPD_gemm5_kernel_19
GRPB_gemm5_kernel_18:
    s_barrier
PPL_gemm5_kernel_26:
    ds_read_b128 v[20:23], v10 offset:0
    ds_read_b128 v[36:39], v10 offset:4096
    ds_read_b64_tr_b16 v[52:53], v14 offset:0
    ds_read_b64_tr_b16 v[54:55], v14 offset:1024
    ds_read_b128 v[24:27], v11 offset:0
    ds_read_b128 v[40:43], v11 offset:4096
    ds_read_b64_tr_b16 v[56:57], v14 offset:4096
    ds_read_b64_tr_b16 v[58:59], v14 offset:5120
    ds_read_b128 v[28:31], v12 offset:0
    ds_read_b128 v[44:47], v12 offset:4096
    ds_read_b64_tr_b16 v[60:61], v14 offset:8192
    ds_read_b64_tr_b16 v[62:63], v14 offset:9216
    ds_read_b128 v[32:35], v13 offset:0
    ds_read_b128 v[48:51], v13 offset:4096
    ds_read_b64_tr_b16 v[64:65], v14 offset:12288
    ds_read_b64_tr_b16 v[66:67], v14 offset:13312
    s_cmp_ge_u32 s31, s27
    s_cbranch_scc1 PPN_gemm5_kernel_27
    s_add_u32 m0, s35, s36
    s_nop 0
    buffer_load_dwordx4 v15, s[4:7], s32 offen lds
    s_add_u32 m0, m0, 1024
    s_nop 0
    buffer_load_dwordx4 v16, s[4:7], s32 offen lds
    s_add_u32 m0, s35, s37
    s_nop 0
    buffer_load_dwordx4 v17, s[8:11], s33 offen lds
    s_add_u32 m0, m0, 1024
    s_nop 0
    buffer_load_dwordx4 v18, s[8:11], s33 offen lds
    s_add_u32 s32, s32, 128
    s_add_u32 s33, s33, s42
    s_add_u32 s31, s31, 1
PPN_gemm5_kernel_27:
    s_add_u32 s38, s43, 4
    s_cmp_eq_u32 s38, s31
    s_cbranch_scc1 PW0_gemm5_kernel_28
    s_waitcnt vmcnt(0) lgkmcnt(0)
    s_branch PW1_gemm5_kernel_29
PW0_gemm5_kernel_28:
    s_waitcnt vmcnt(8) lgkmcnt(0)
PW1_gemm5_kernel_29:
    s_barrier
    s_setprio 1
    v_mfma_f32_32x32x16_bf16 v[80:95], v[52:55], v[20:23], v[80:95]
    v_mfma_f32_32x32x16_bf16 v[96:111], v[52:55], v[36:39], v[96:111]
    v_mfma_f32_32x32x16_bf16 v[80:95], v[56:59], v[24:27], v[80:95]
    v_mfma_f32_32x32x16_bf16 v[96:111], v[56:59], v[40:43], v[96:111]
    v_mfma_f32_32x32x16_bf16 v[80:95], v[60:63], v[28:31], v[80:95]
    v_mfma_f32_32x32x16_bf16 v[96:111], v[60:63], v[44:47], v[96:111]
    v_mfma_f32_32x32x16_bf16 v[80:95], v[64:67], v[32:35], v[80:95]
    v_mfma_f32_32x32x16_bf16 v[96:111], v[64:67], v[48:51], v[96:111]
    s_setprio 0
    s_mov_b32 s39, s34
    s_add_u32 s34, s34, 32768
    s_cmp_eq_u32 s34, 131072
    s_cselect_b32 s34, 0, s34
    s_sub_u32 s38, s34, s39
    v_add_u32 v10, s38, v10
    v_add_u32 v11, s38, v11
    v_add_u32 v12, s38, v12
    v_add_u32 v13, s38, v13
    v_add_u32 v14, s38, v14
    s_add_u32 s35, s35, 32768
    s_cmp_eq_u32 s35, 131072
    s_cselect_b32 s35, 0, s35
    s_add_u32 s43, s43, 1
    s_barrier
    s_cmp_lt_u32 s43, s27
    s_cbranch_scc1 PPL_gemm5_kernel_26
PPD_gemm5_kernel_19:
    s_sub_u32 s38, 0, s34
    v_add_u32 v10, s38, v10
    v_add_u32 v11, s38, v11
    v_add_u32 v12, s38, v12
    v_add_u32 v13, s38, v13
    v_add_u32 v14, s38, v14
    s_nop 15
    s_nop 7
    s_lshl_b32 s61, s60, 2
    v_mov_b32 v1, s61
    s_mov_b32 s62, 0
POLL_gemm5_kernel_32:
    buffer_load_dword v2, v1, s[56:59], 0 offen sc1
    s_waitcnt vmcnt(0)
    v_readfirstlane_b32 s63, v2
    s_cmp_eq_u32 s63, 0x5a5a
    s_cbranch_scc1 GOT_gemm5_kernel_33
    s_sleep 2
    s_add_u32 s62, s62, 1
    s_cmp_lt_u32 s62, 0x400000
    s_cbranch_scc1 POLL_gemm5_kernel_32
GOT_gemm5_kernel_33:
    s_barrier
    s_lshl_b32 s61, s60, 16
    s_mul_i32 s62, s30, 8192
    s_add_u32 s61, s61, s62
    v_and_b32 v1, 63, v0
    v_lshlrev_b32 v1, 4, v1
    buffer_load_dwordx4 v[20:23], v1, s[52:55], s61 offen offset:0 sc1
    buffer_load_dwordx4 v[24:27], v1, s[52:55], s61 offen offset:1024 sc1
    buffer_load_dwordx4 v[28:31], v1, s[52:55], s61 offen offset:2048 sc1
    buffer_load_dwordx4 v[32:35], v1, s[52:55], s61 offen offset:3072 sc1
    s_add_u32 s61, s61, 4096
    buffer_load_dwordx4 v[36:39], v1, s[52:55], s61 offen offset:0 sc1
    buffer_load_dwordx4 v[40:43], v1, s[52:55], s61 offen offset:1024 sc1
    buffer_load_dwordx4 v[44:47], v1, s[52:55], s61 offen offset:2048 sc1
    buffer_load_dwordx4 v[48:51], v1, s[52:55], s61 offen offset:3072 sc1
    s_waitcnt vmcnt(0)
    v_add_f32 v80, v80, v20
    v_add_f32 v81, v81, v21
    v_add_f32 v82, v82, v22
    v_add_f32 v83, v83, v23
    v_add_f32 v84, v84, v24
    v_add_f32 v85, v85, v25
    v_add_f32 v86, v86, v26
    v_add_f32 v87, v87, v27
    v_add_f32 v88, v88, v28
    v_add_f32 v89, v89, v29
    v_add_f32 v90, v90, v30
    v_add_f32 v91, v91, v31
    v_add_f32 v92, v92, v32
    v_add_f32 v93, v93, v33
    v_add_f32 v94, v94, v34
    v_add_f32 v95, v95, v35
    v_add_f32 v96, v96, v36
    v_add_f32 v97, v97, v37
    v_add_f32 v98, v98, v38
    v_add_f32 v99, v99, v39
    v_add_f32 v100, v100, v40
    v_add_f32 v101, v101, v41
    v_add_f32 v102, v102, v42
    v_add_f32 v103, v103, v43
    v_add_f32 v104, v104, v44
    v_add_f32 v105, v105, v45
    v_add_f32 v106, v106, v46
    v_add_f32 v107, v107, v47
    v_add_f32 v108, v108, v48
    v_add_f32 v109, v109, v49
    v_add_f32 v110, v110, v50
    v_add_f32 v111, v111, v51
    v_and_b32 v1, 63, v0
    v_lshrrev_b32 v2, 4, v1
    s_mul_i32 s38, s30, 16
    v_add_u32 v2, s38, v2
    v_and_b32 v3, 15, v1
    v_and_b32 v4, 7, v2
    v_lshlrev_b32 v5, 1, v3
    v_xor_b32 v4, v4, v5
    v_mul_u32_u24 v5, 512, v2
    v_lshl_add_u32 v5, v4, 4, v5
    v_add_u32 v4, s28, v2
    v_mul_lo_u32 v6, v4, s26
    v_lshl_add_u32 v6, v3, 4, v6
    s_lshl_b32 s38, s29, 1
    v_add_u32 v6, s38, v6
    v_lshlrev_b32 v7, 2, v4
    s_mul_i32 s39, s26, 0
    buffer_load_dwordx4 v[48:51], v6, s[16:19], s39 offen
    buffer_load_dword v64, v7, s[20:23], 0 offen offset:0
    s_mul_i32 s39, s26, 4
    buffer_load_dwordx4 v[52:55], v6, s[16:19], s39 offen
    buffer_load_dword v65, v7, s[20:23], 0 offen offset:16
    s_mul_i32 s39, s26, 8
    buffer_load_dwordx4 v[56:59], v6, s[16:19], s39 offen
    buffer_load_dword v66, v7, s[20:23], 0 offen offset:32
    s_mul_i32 s39, s26, 12
    buffer_load_dwordx4 v[60:63], v6, s[16:19], s39 offen
    buffer_load_dword v67, v7, s[20:23], 0 offen offset:48
    s_nop 15
    s_nop 7
    s_and_b32 s42, s30, 1
    s_lshr_b32 s43, s30, 1
    v_and_b32 v1, 31, v0
    s_mul_i32 s38, s42, 64
    v_add_u32 v1, s38, v1
    v_mul_u32_u24 v2, 512, v1
    v_and_b32 v1, 7, v0
    v_bfe_u32 v3, v0, 5, 1
    v_xor_b32 v1, v1, v3
    s_mul_i32 s38, s43, 8
    v_xor_b32 v1, s38, v1
    v_lshl_add_u32 v2, v1, 4, v2
    v_xor_b32 v1, 0, v2
    ds_write_b128 v1, v[80:83] offset:0
    v_xor_b32 v1, 32, v2
    ds_write_b128 v1, v[84:87] offset:0
    v_xor_b32 v1, 64, v2
    ds_write_b128 v1, v[88:91] offset:0
    v_xor_b32 v1, 96, v2
    ds_write_b128 v1, v[92:95] offset:0
    v_xor_b32 v1, 0, v2
    ds_write_b128 v1, v[96:99] offset:16384
    v_xor_b32 v1, 32, v2
    ds_write_b128 v1, v[100:103] offset:16384
    v_xor_b32 v1, 64, v2
    ds_write_b128 v1, v[104:107] offset:16384
    v_xor_b32 v1, 96, v2
    ds_write_b128 v1, v[108:111] offset:16384
    v_add_u32 v2, 65536, v2
    v_xor_b32 v1, 0, v2
    ds_write_b128 v1, v[112:115] offset:0
    v_xor_b32 v1, 32, v2
    ds_write_b128 v1, v[116:119] offset:0
    v_xor_b32 v1, 64, v2
    ds_write_b128 v1, v[120:123] offset:0
    v_xor_b32 v1, 96, v2
    ds_write_b128 v1, v[124:127] offset:0
    v_xor_b32 v1, 0, v2
    ds_write_b128 v1, v[128:131] offset:16384
    v_xor_b32 v1, 32, v2
    ds_write_b128 v1, v[132:135] offset:16384
    v_xor_b32 v1, 64, v2
    ds_write_b128 v1, v[136:139] offset:16384
    v_xor_b32 v1, 96, v2
    ds_write_b128 v1, v[140:143] offset:16384
    s_waitcnt lgkmcnt(0)
    s_barrier
    s_mov_b32 s39, 0
    s_mul_i32 s43, s26, 4
    v_xor_b32 v1, 16, v5
    ds_read_b128 v[20:23], v5
    ds_read_b128 v[24:27], v1
    v_add_u32 v2, 65536, v5
    v_add_u32 v3, 65536, v1
    ds_read_b128 v[28:31], v2
    ds_read_b128 v[32:35], v3
    s_waitcnt vmcnt(0) lgkmcnt(0)
    v_sub_f32 v38, 1.0, v64
    v_cvt_pk_bf16_f32 v38, v38, v38
    v_lshlrev_b32 v38, 16, v38
    v_cvt_pk_bf16_f32 v36, v20, v21
    v_lshlrev_b32 v20, 16, v36
    v_and_b32 v21, 0xffff0000, v36
    v_lshlrev_b32 v36, 16, v48
    v_and_b32 v37, 0xffff0000, v48
    v_pk_add_f32 v[20:21], v[20:21], v[36:37]
    v_cvt_pk_bf16_f32 v36, v20, v21
    v_lshlrev_b32 v20, 16, v36
    v_and_b32 v21, 0xffff0000, v36
    v_mul_f32 v20, v20, v38
    v_mul_f32 v21, v21, v38
    v_cvt_pk_bf16_f32 v36, v20, v21
    v_lshlrev_b32 v20, 16, v36
    v_and_b32 v21, 0xffff0000, v36
    v_cvt_pk_bf16_f32 v36, v28, v29
    v_lshlrev_b32 v28, 16, v36
    v_and_b32 v29, 0xffff0000, v36
    v_mul_f32 v28, v28, v64
    v_mul_f32 v29, v29, v64
    v_cvt_pk_bf16_f32 v36, v28, v29
    v_lshlrev_b32 v28, 16, v36
    v_and_b32 v29, 0xffff0000, v36
    v_pk_add_f32 v[20:21], v[20:21], v[28:29]
    v_cvt_pk_bf16_f32 v44, v20, v21
    v_cvt_pk_bf16_f32 v36, v22, v23
    v_lshlrev_b32 v22, 16, v36
    v_and_b32 v23, 0xffff0000, v36
    v_lshlrev_b32 v36, 16, v49
    v_and_b32 v37, 0xffff0000, v49
    v_pk_add_f32 v[22:23], v[22:23], v[36:37]
    v_cvt_pk_bf16_f32 v36, v22, v23
    v_lshlrev_b32 v22, 16, v36
    v_and_b32 v23, 0xffff0000, v36
    v_mul_f32 v22, v22, v38
    v_mul_f32 v23, v23, v38
    v_cvt_pk_bf16_f32 v36, v22, v23
    v_lshlrev_b32 v22, 16, v36
    v_and_b32 v23, 0xffff0000, v36
    v_cvt_pk_bf16_f32 v36, v30, v31
    v_lshlrev_b32 v30, 16, v36
    v_and_b32 v31, 0xffff0000, v36
    v_mul_f32 v30, v30, v64
    v_mul_f32 v31, v31, v64
    v_cvt_pk_bf16_f32 v36, v30, v31
    v_lshlrev_b32 v30, 16, v36
    v_and_b32 v31, 0xffff0000, v36
    v_pk_add_f32 v[22:23], v[22:23], v[30:31]
    v_cvt_pk_bf16_f32 v45, v22, v23
    v_cvt_pk_bf16_f32 v36, v24, v25
    v_lshlrev_b32 v24, 16, v36
    v_and_b32 v25, 0xffff0000, v36
    v_lshlrev_b32 v36, 16, v50
    v_and_b32 v37, 0xffff0000, v50
    v_pk_add_f32 v[24:25], v[24:25], v[36:37]
    v_cvt_pk_bf16_f32 v36, v24, v25
    v_lshlrev_b32 v24, 16, v36
    v_and_b32 v25, 0xffff0000, v36
    v_mul_f32 v24, v24, v38
    v_mul_f32 v25, v25, v38
    v_cvt_pk_bf16_f32 v36, v24, v25
    v_lshlrev_b32 v24, 16, v36
    v_and_b32 v25, 0xffff0000, v36
    v_cvt_pk_bf16_f32 v36, v32, v33
    v_lshlrev_b32 v32, 16, v36
    v_and_b32 v33, 0xffff0000, v36
    v_mul_f32 v32, v32, v64
    v_mul_f32 v33, v33, v64
    v_cvt_pk_bf16_f32 v36, v32, v33
    v_lshlrev_b32 v32, 16, v36
    v_and_b32 v33, 0xffff0000, v36
    v_pk_add_f32 v[24:25], v[24:25], v[32:33]
    v_cvt_pk_bf16_f32 v46, v24, v25
    v_cvt_pk_bf16_f32 v36, v26, v27
    v_lshlrev_b32 v26, 16, v36
    v_and_b32 v27, 0xffff0000, v36
    v_lshlrev_b32 v36, 16, v51
    v_and_b32 v37, 0xffff0000, v51
    v_pk_add_f32 v[26:27], v[26:27], v[36:37]
    v_cvt_pk_bf16_f32 v36, v26, v27
    v_lshlrev_b32 v26, 16, v36
    v_and_b32 v27, 0xffff0000, v36
    v_mul_f32 v26, v26, v38
    v_mul_f32 v27, v27, v38
    v_cvt_pk_bf16_f32 v36, v26, v27
    v_lshlrev_b32 v26, 16, v36
    v_and_b32 v27, 0xffff0000, v36
    v_cvt_pk_bf16_f32 v36, v34, v35
    v_lshlrev_b32 v34, 16, v36
    v_and_b32 v35, 0xffff0000, v36
    v_mul_f32 v34, v34, v64
    v_mul_f32 v35, v35, v64
    v_cvt_pk_bf16_f32 v36, v34, v35
    v_lshlrev_b32 v34, 16, v36
    v_and_b32 v35, 0xffff0000, v36
    v_pk_add_f32 v[26:27], v[26:27], v[34:35]
    v_cvt_pk_bf16_f32 v47, v26, v27
    buffer_store_dwordx4 v[44:47], v6, s[12:15], s39 offen
    v_add_u32 v5, 2048, v5
    v_xor_b32 v5, 64, v5
    s_add_u32 s39, s39, s43
    v_xor_b32 v1, 16, v5
    ds_read_b128 v[20:23], v5
    ds_read_b128 v[24:27], v1
    v_add_u32 v2, 65536, v5
    v_add_u32 v3, 65536, v1
    ds_read_b128 v[28:31], v2
    ds_read_b128 v[32:35], v3
    s_waitcnt lgkmcnt(0)
    v_sub_f32 v38, 1.0, v65
    v_cvt_pk_bf16_f32 v38, v38, v38
    v_lshlrev_b32 v38, 16, v38
    v_cvt_pk_bf16_f32 v36, v20, v21
    v_lshlrev_b32 v20, 16, v36
    v_and_b32 v21, 0xffff0000, v36
    v_lshlrev_b32 v36, 16, v52
    v_and_b32 v37, 0xffff0000, v52
    v_pk_add_f32 v[20:21], v[20:21], v[36:37]
    v_cvt_pk_bf16_f32 v36, v20, v21
    v_lshlrev_b32 v20, 16, v36
    v_and_b32 v21, 0xffff0000, v36
    v_mul_f32 v20, v20, v38
    v_mul_f32 v21, v21, v38
    v_cvt_pk_bf16_f32 v36, v20, v21
    v_lshlrev_b32 v20, 16, v36
    v_and_b32 v21, 0xffff0000, v36
    v_cvt_pk_bf16_f32 v36, v28, v29
    v_lshlrev_b32 v28, 16, v36
    v_and_b32 v29, 0xffff0000, v36
    v_mul_f32 v28, v28, v65
    v_mul_f32 v29, v29, v65
    v_cvt_pk_bf16_f32 v36, v28, v29
    v_lshlrev_b32 v28, 16, v36
    v_and_b32 v29, 0xffff0000, v36
    v_pk_add_f32 v[20:21], v[20:21], v[28:29]
    v_cvt_pk_bf16_f32 v44, v20, v21
    v_cvt_pk_bf16_f32 v36, v22, v23
    v_lshlrev_b32 v22, 16, v36
    v_and_b32 v23, 0xffff0000, v36
    v_lshlrev_b32 v36, 16, v53
    v_and_b32 v37, 0xffff0000, v53
    v_pk_add_f32 v[22:23], v[22:23], v[36:37]
    v_cvt_pk_bf16_f32 v36, v22, v23
    v_lshlrev_b32 v22, 16, v36
    v_and_b32 v23, 0xffff0000, v36
    v_mul_f32 v22, v22, v38
    v_mul_f32 v23, v23, v38
    v_cvt_pk_bf16_f32 v36, v22, v23
    v_lshlrev_b32 v22, 16, v36
    v_and_b32 v23, 0xffff0000, v36
    v_cvt_pk_bf16_f32 v36, v30, v31
    v_lshlrev_b32 v30, 16, v36
    v_and_b32 v31, 0xffff0000, v36
    v_mul_f32 v30, v30, v65
    v_mul_f32 v31, v31, v65
    v_cvt_pk_bf16_f32 v36, v30, v31
    v_lshlrev_b32 v30, 16, v36
    v_and_b32 v31, 0xffff0000, v36
    v_pk_add_f32 v[22:23], v[22:23], v[30:31]
    v_cvt_pk_bf16_f32 v45, v22, v23
    v_cvt_pk_bf16_f32 v36, v24, v25
    v_lshlrev_b32 v24, 16, v36
    v_and_b32 v25, 0xffff0000, v36
    v_lshlrev_b32 v36, 16, v54
    v_and_b32 v37, 0xffff0000, v54
    v_pk_add_f32 v[24:25], v[24:25], v[36:37]
    v_cvt_pk_bf16_f32 v36, v24, v25
    v_lshlrev_b32 v24, 16, v36
    v_and_b32 v25, 0xffff0000, v36
    v_mul_f32 v24, v24, v38
    v_mul_f32 v25, v25, v38
    v_cvt_pk_bf16_f32 v36, v24, v25
    v_lshlrev_b32 v24, 16, v36
    v_and_b32 v25, 0xffff0000, v36
    v_cvt_pk_bf16_f32 v36, v32, v33
    v_lshlrev_b32 v32, 16, v36
    v_and_b32 v33, 0xffff0000, v36
    v_mul_f32 v32, v32, v65
    v_mul_f32 v33, v33, v65
    v_cvt_pk_bf16_f32 v36, v32, v33
    v_lshlrev_b32 v32, 16, v36
    v_and_b32 v33, 0xffff0000, v36
    v_pk_add_f32 v[24:25], v[24:25], v[32:33]
    v_cvt_pk_bf16_f32 v46, v24, v25
    v_cvt_pk_bf16_f32 v36, v26, v27
    v_lshlrev_b32 v26, 16, v36
    v_and_b32 v27, 0xffff0000, v36
    v_lshlrev_b32 v36, 16, v55
    v_and_b32 v37, 0xffff0000, v55
    v_pk_add_f32 v[26:27], v[26:27], v[36:37]
    v_cvt_pk_bf16_f32 v36, v26, v27
    v_lshlrev_b32 v26, 16, v36
    v_and_b32 v27, 0xffff0000, v36
    v_mul_f32 v26, v26, v38
    v_mul_f32 v27, v27, v38
    v_cvt_pk_bf16_f32 v36, v26, v27
    v_lshlrev_b32 v26, 16, v36
    v_and_b32 v27, 0xffff0000, v36
    v_cvt_pk_bf16_f32 v36, v34, v35
    v_lshlrev_b32 v34, 16, v36
    v_and_b32 v35, 0xffff0000, v36
    v_mul_f32 v34, v34, v65
    v_mul_f32 v35, v35, v65
    v_cvt_pk_bf16_f32 v36, v34, v35
    v_lshlrev_b32 v34, 16, v36
    v_and_b32 v35, 0xffff0000, v36
    v_pk_add_f32 v[26:27], v[26:27], v[34:35]
    v_cvt_pk_bf16_f32 v47, v26, v27
    buffer_store_dwordx4 v[44:47], v6, s[12:15], s39 offen
    v_add_u32 v5, 2048, v5
    v_xor_b32 v5, 64, v5
    s_add_u32 s39, s39, s43
    v_xor_b32 v1, 16, v5
    ds_read_b128 v[20:23], v5
    ds_read_b128 v[24:27], v1
    v_add_u32 v2, 65536, v5
    v_add_u32 v3, 65536, v1
    ds_read_b128 v[28:31], v2
    ds_read_b128 v[32:35], v3
    s_waitcnt lgkmcnt(0)
    v_sub_f32 v38, 1.0, v66
    v_cvt_pk_bf16_f32 v38, v38, v38
    v_lshlrev_b32 v38, 16, v38
    v_cvt_pk_bf16_f32 v36, v20, v21
    v_lshlrev_b32 v20, 16, v36
    v_and_b32 v21, 0xffff0000, v36
    v_lshlrev_b32 v36, 16, v56
    v_and_b32 v37, 0xffff0000, v56
    v_pk_add_f32 v[20:21], v[20:21], v[36:37]
    v_cvt_pk_bf16_f32 v36, v20, v21
    v_lshlrev_b32 v20, 16, v36
    v_and_b32 v21, 0xffff0000, v36
    v_mul_f32 v20, v20, v38
    v_mul_f32 v21, v21, v38
    v_cvt_pk_bf16_f32 v36, v20, v21
    v_lshlrev_b32 v20, 16, v36
    v_and_b32 v21, 0xffff0000, v36
    v_cvt_pk_bf16_f32 v36, v28, v29
    v_lshlrev_b32 v28, 16, v36
    v_and_b32 v29, 0xffff0000, v36
    v_mul_f32 v28, v28, v66
    v_mul_f32 v29, v29, v66
    v_cvt_pk_bf16_f32 v36, v28, v29
    v_lshlrev_b32 v28, 16, v36
    v_and_b32 v29, 0xffff0000, v36
    v_pk_add_f32 v[20:21], v[20:21], v[28:29]
    v_cvt_pk_bf16_f32 v44, v20, v21
    v_cvt_pk_bf16_f32 v36, v22, v23
    v_lshlrev_b32 v22, 16, v36
    v_and_b32 v23, 0xffff0000, v36
    v_lshlrev_b32 v36, 16, v57
    v_and_b32 v37, 0xffff0000, v57
    v_pk_add_f32 v[22:23], v[22:23], v[36:37]
    v_cvt_pk_bf16_f32 v36, v22, v23
    v_lshlrev_b32 v22, 16, v36
    v_and_b32 v23, 0xffff0000, v36
    v_mul_f32 v22, v22, v38
    v_mul_f32 v23, v23, v38
    v_cvt_pk_bf16_f32 v36, v22, v23
    v_lshlrev_b32 v22, 16, v36
    v_and_b32 v23, 0xffff0000, v36
    v_cvt_pk_bf16_f32 v36, v30, v31
    v_lshlrev_b32 v30, 16, v36
    v_and_b32 v31, 0xffff0000, v36
    v_mul_f32 v30, v30, v66
    v_mul_f32 v31, v31, v66
    v_cvt_pk_bf16_f32 v36, v30, v31
    v_lshlrev_b32 v30, 16, v36
    v_and_b32 v31, 0xffff0000, v36
    v_pk_add_f32 v[22:23], v[22:23], v[30:31]
    v_cvt_pk_bf16_f32 v45, v22, v23
    v_cvt_pk_bf16_f32 v36, v24, v25
    v_lshlrev_b32 v24, 16, v36
    v_and_b32 v25, 0xffff0000, v36
    v_lshlrev_b32 v36, 16, v58
    v_and_b32 v37, 0xffff0000, v58
    v_pk_add_f32 v[24:25], v[24:25], v[36:37]
    v_cvt_pk_bf16_f32 v36, v24, v25
    v_lshlrev_b32 v24, 16, v36
    v_and_b32 v25, 0xffff0000, v36
    v_mul_f32 v24, v24, v38
    v_mul_f32 v25, v25, v38
    v_cvt_pk_bf16_f32 v36, v24, v25
    v_lshlrev_b32 v24, 16, v36
    v_and_b32 v25, 0xffff0000, v36
    v_cvt_pk_bf16_f32 v36, v32, v33
    v_lshlrev_b32 v32, 16, v36
    v_and_b32 v33, 0xffff0000, v36
    v_mul_f32 v32, v32, v66
    v_mul_f32 v33, v33, v66
    v_cvt_pk_bf16_f32 v36, v32, v33
    v_lshlrev_b32 v32, 16, v36
    v_and_b32 v33, 0xffff0000, v36
    v_pk_add_f32 v[24:25], v[24:25], v[32:33]
    v_cvt_pk_bf16_f32 v46, v24, v25
    v_cvt_pk_bf16_f32 v36, v26, v27
    v_lshlrev_b32 v26, 16, v36
    v_and_b32 v27, 0xffff0000, v36
    v_lshlrev_b32 v36, 16, v59
    v_and_b32 v37, 0xffff0000, v59
    v_pk_add_f32 v[26:27], v[26:27], v[36:37]
    v_cvt_pk_bf16_f32 v36, v26, v27
    v_lshlrev_b32 v26, 16, v36
    v_and_b32 v27, 0xffff0000, v36
    v_mul_f32 v26, v26, v38
    v_mul_f32 v27, v27, v38
    v_cvt_pk_bf16_f32 v36, v26, v27
    v_lshlrev_b32 v26, 16, v36
    v_and_b32 v27, 0xffff0000, v36
    v_cvt_pk_bf16_f32 v36, v34, v35
    v_lshlrev_b32 v34, 16, v36
    v_and_b32 v35, 0xffff0000, v36
    v_mul_f32 v34, v34, v66
    v_mul_f32 v35, v35, v66
    v_cvt_pk_bf16_f32 v36, v34, v35
    v_lshlrev_b32 v34, 16, v36
    v_and_b32 v35, 0xffff0000, v36
    v_pk_add_f32 v[26:27], v[26:27], v[34:35]
    v_cvt_pk_bf16_f32 v47, v26, v27
    buffer_store_dwordx4 v[44:47], v6, s[12:15], s39 offen
    v_add_u32 v5, 2048, v5
    v_xor_b32 v5, 64, v5
    s_add_u32 s39, s39, s43
    v_xor_b32 v1, 16, v5
    ds_read_b128 v[20:23], v5
    ds_read_b128 v[24:27], v1
    v_add_u32 v2, 65536, v5
    v_add_u32 v3, 65536, v1
    ds_read_b128 v[28:31], v2
    ds_read_b128 v[32:35], v3
    s_waitcnt lgkmcnt(0)
    v_sub_f32 v38, 1.0, v67
    v_cvt_pk_bf16_f32 v38, v38, v38
    v_lshlrev_b32 v38, 16, v38
    v_cvt_pk_bf16_f32 v36, v20, v21
    v_lshlrev_b32 v20, 16, v36
    v_and_b32 v21, 0xffff0000, v36
    v_lshlrev_b32 v36, 16, v60
    v_and_b32 v37, 0xffff0000, v60
    v_pk_add_f32 v[20:21], v[20:21], v[36:37]
    v_cvt_pk_bf16_f32 v36, v20, v21
    v_lshlrev_b32 v20, 16, v36
    v_and_b32 v21, 0xffff0000, v36
    v_mul_f32 v20, v20, v38
    v_mul_f32 v21, v21, v38
    v_cvt_pk_bf16_f32 v36, v20, v21
    v_lshlrev_b32 v20, 16, v36
    v_and_b32 v21, 0xffff0000, v36
    v_cvt_pk_bf16_f32 v36, v28, v29
    v_lshlrev_b32 v28, 16, v36
    v_and_b32 v29, 0xffff0000, v36
    v_mul_f32 v28, v28, v67
    v_mul_f32 v29, v29, v67
    v_cvt_pk_bf16_f32 v36, v28, v29
    v_lshlrev_b32 v28, 16, v36
    v_and_b32 v29, 0xffff0000, v36
    v_pk_add_f32 v[20:21], v[20:21], v[28:29]
    v_cvt_pk_bf16_f32 v44, v20, v21
    v_cvt_pk_bf16_f32 v36, v22, v23
    v_lshlrev_b32 v22, 16, v36
    v_and_b32 v23, 0xffff0000, v36
    v_lshlrev_b32 v36, 16, v61
    v_and_b32 v37, 0xffff0000, v61
    v_pk_add_f32 v[22:23], v[22:23], v[36:37]
    v_cvt_pk_bf16_f32 v36, v22, v23
    v_lshlrev_b32 v22, 16, v36
    v_and_b32 v23, 0xffff0000, v36
    v_mul_f32 v22, v22, v38
    v_mul_f32 v23, v23, v38
    v_cvt_pk_bf16_f32 v36, v22, v23
    v_lshlrev_b32 v22, 16, v36
    v_and_b32 v23, 0xffff0000, v36
    v_cvt_pk_bf16_f32 v36, v30, v31
    v_lshlrev_b32 v30, 16, v36
    v_and_b32 v31, 0xffff0000, v36
    v_mul_f32 v30, v30, v67
    v_mul_f32 v31, v31, v67
    v_cvt_pk_bf16_f32 v36, v30, v31
    v_lshlrev_b32 v30, 16, v36
    v_and_b32 v31, 0xffff0000, v36
    v_pk_add_f32 v[22:23], v[22:23], v[30:31]
    v_cvt_pk_bf16_f32 v45, v22, v23
    v_cvt_pk_bf16_f32 v36, v24, v25
    v_lshlrev_b32 v24, 16, v36
    v_and_b32 v25, 0xffff0000, v36
    v_lshlrev_b32 v36, 16, v62
    v_and_b32 v37, 0xffff0000, v62
    v_pk_add_f32 v[24:25], v[24:25], v[36:37]
    v_cvt_pk_bf16_f32 v36, v24, v25
    v_lshlrev_b32 v24, 16, v36
    v_and_b32 v25, 0xffff0000, v36
    v_mul_f32 v24, v24, v38
    v_mul_f32 v25, v25, v38
    v_cvt_pk_bf16_f32 v36, v24, v25
    v_lshlrev_b32 v24, 16, v36
    v_and_b32 v25, 0xffff0000, v36
    v_cvt_pk_bf16_f32 v36, v32, v33
    v_lshlrev_b32 v32, 16, v36
    v_and_b32 v33, 0xffff0000, v36
    v_mul_f32 v32, v32, v67
    v_mul_f32 v33, v33, v67
    v_cvt_pk_bf16_f32 v36, v32, v33
    v_lshlrev_b32 v32, 16, v36
    v_and_b32 v33, 0xffff0000, v36
    v_pk_add_f32 v[24:25], v[24:25], v[32:33]
    v_cvt_pk_bf16_f32 v46, v24, v25
    v_cvt_pk_bf16_f32 v36, v26, v27
    v_lshlrev_b32 v26, 16, v36
    v_and_b32 v27, 0xffff0000, v36
    v_lshlrev_b32 v36, 16, v63
    v_and_b32 v37, 0xffff0000, v63
    v_pk_add_f32 v[26:27], v[26:27], v[36:37]
    v_cvt_pk_bf16_f32 v36, v26, v27
    v_lshlrev_b32 v26, 16, v36
    v_and_b32 v27, 0xffff0000, v36
    v_mul_f32 v26, v26, v38
    v_mul_f32 v27, v27, v38
    v_cvt_pk_bf16_f32 v36, v26, v27
    v_lshlrev_b32 v26, 16, v36
    v_and_b32 v27, 0xffff0000, v36
    v_cvt_pk_bf16_f32 v36, v34, v35
    v_lshlrev_b32 v34, 16, v36
    v_and_b32 v35, 0xffff0000, v36
    v_mul_f32 v34, v34, v67
    v_mul_f32 v35, v35, v67
    v_cvt_pk_bf16_f32 v36, v34, v35
    v_lshlrev_b32 v34, 16, v36
    v_and_b32 v35, 0xffff0000, v36
    v_pk_add_f32 v[26:27], v[26:27], v[34:35]
    v_cvt_pk_bf16_f32 v47, v26, v27
    buffer_store_dwordx4 v[44:47], v6, s[12:15], s39 offen
    v_add_u32 v5, 2048, v5
    v_xor_b32 v5, 64, v5
    s_add_u32 s39, s39, s43
    s_endpgm
HALF1_gemm5_kernel_2:
    s_add_u32 s4, s48, 0x1c00000
    s_addc_u32 s5, s49, 0
    s_mov_b32 s6, 0xe00000
    s_mov_b32 s7, 0x00020000
    s_add_u32 s8, s46, 0x0
    s_addc_u32 s9, s47, 0
    s_mov_b32 s10, 0x700000
    s_mov_b32 s11, 0x00020000
    s_mov_b32 s24, 7168
    s_mov_b32 s27, 36
    v_and_b32 v1, 63, v0
    v_lshrrev_b32 v2, 3, v1
    s_mul_i32 s38, s30, 16
    v_add_u32 v2, s38, v2
    v_mul_lo_u32 v2, v2, s24
    v_and_b32 v3, 7, v1
    v_lshrrev_b32 v4, 4, v1
    v_xor_b32 v3, v3, v4
    s_mul_i32 s38, s30, 2
    s_add_u32 s38, s38, 0
    s_and_b32 s38, s38, 1
    s_lshl_b32 s38, s38, 2
    v_xor_b32 v4, s38, v3
    v_lshl_add_u32 v15, v4, 4, v2
    s_lshl_b32 s38, s24, 3
    v_add_u32 v2, s38, v2
    s_mul_i32 s38, s30, 2
    s_add_u32 s38, s38, 1
    s_and_b32 s38, s38, 1
    s_lshl_b32 s38, s38, 2
    v_xor_b32 v4, s38, v3
    v_lshl_add_u32 v16, v4, 4, v2
    v_lshrrev_b32 v2, 4, v1
    s_mul_i32 s38, s30, 8
    v_add_u32 v3, s38, v2
    v_mul_lo_u32 v3, v3, s25
    v_lshlrev_b32 v2, 2, v2
    v_and_b32 v4, 15, v1
    v_xor_b32 v4, v4, v2
    v_lshl_add_u32 v17, v4, 4, v3
    s_lshl_b32 s38, s25, 2
    v_add_u32 v3, s38, v3
    v_lshl_add_u32 v18, v4, 4, v3
    s_mul_i32 s36, s30, 2048
    s_mul_i32 s37, s30, 2048
    s_add_u32 s37, s37, 16384
    s_and_b32 s42, s30, 1
    s_lshr_b32 s43, s30, 1
    v_and_b32 v2, 31, v1
    s_mul_i32 s38, s42, 64
    v_add_u32 v2, s38, v2
    v_lshlrev_b32 v2, 7, v2
    v_lshrrev_b32 v3, 5, v1
    v_bfe_u32 v4, v1, 1, 3
    v_xor_b32 v3, v3, v4
    v_xor_b32 v4, 0, v3
    v_lshl_add_u32 v10, v4, 4, v2
    v_xor_b32 v4, 2, v3
    v_lshl_add_u32 v11, v4, 4, v2
    v_xor_b32 v4, 4, v3
    v_lshl_add_u32 v12, v4, 4, v2
    v_xor_b32 v4, 6, v3
    v_lshl_add_u32 v13, v4, 4, v2
    v_bfe_u32 v2, v1, 2, 2
    v_lshrrev_b32 v3, 5, v1
    v_lshl_add_u32 v3, v3, 3, v2
    v_mul_u32_u24 v3, 256, v3
    v_bfe_u32 v4, v1, 4, 1
    v_lshl_add_u32 v3, v4, 5, v3
    v_and_b32 v4, 3, v1
    v_lshl_add_u32 v3, v4, 3, v3
    v_add_u32 v3, 16384, v3
    s_mul_i32 s38, s43, 1
    s_add_u32 s38, s38, 0
    v_xor_b32 v4, s38, v2
    v_lshl_add_u32 v14, v4, 6, v3
    s_mul_i32 s32, s28, s24
    s_add_u32 s32, s32, 2560
    s_lshl_b32 s33, s29, 1
    s_add_u32 s33, s33, 2621440
    s_lshl_b32 s42, s25, 6
    v_mov_b32 v80, 0
    v_mov_b32 v81, 0
    v_mov_b32 v82, 0
    v_mov_b32 v83, 0
    v_mov_b32 v84, 0
    v_mov_b32 v85, 0
    v_mov_b32 v86, 0
    v_mov_b32 v87, 0
    v_mov_b32 v88, 0
    v_mov_b32 v89, 0
    v_mov_b32 v90, 0
    v_mov_b32 v91, 0
    v_mov_b32 v92, 0
    v_mov_b32 v93, 0
    v_mov_b32 v94, 0
    v_mov_b32 v95, 0
    v_mov_b32 v96, 0
    v_mov_b32 v97, 0
    v_mov_b32 v98, 0
    v_mov_b32 v99, 0
    v_mov_b32 v100, 0
    v_mov_b32 v101, 0
    v_mov_b32 v102, 0
    v_mov_b32 v103, 0
    v_mov_b32 v104, 0
    v_mov_b32 v105, 0
    v_mov_b32 v106, 0
    v_mov_b32 v107, 0
    v_mov_b32 v108, 0
    v_mov_b32 v109, 0
    v_mov_b32 v110, 0
    v_mov_b32 v111, 0
    s_mov_b32 s31, 0
    s_mov_b32 s35, 0
    s_add_u32 m0, s35, s36
    s_nop 0
    buffer_load_dwordx4 v15, s[4:7], s32 offen lds
    s_add_u32 m0, m0, 1024
    s_nop 0
    buffer_load_dwordx4 v16, s[4:7], s32 offen lds
    s_add_u32 m0, s35, s37
    s_nop 0
    buffer_load_dwordx4 v17, s[8:11], s33 offen lds
    s_add_u32 m0, m0, 1024
    s_nop 0
    buffer_load_dwordx4 v18, s[8:11], s33 offen lds
    s_add_u32 s32, s32, 128
    s_add_u32 s33, s33, s42
    s_add_u32 s31, s31, 1
    s_mov_b32 s35, 32768
    s_add_u32 m0, s35, s36
    s_nop 0
    buffer_load_dwordx4 v15, s[4:7], s32 offen lds
    s_add_u32 m0, m0, 1024
    s_nop 0
    buffer_load_dwordx4 v16, s[4:7], s32 offen lds
    s_add_u32 m0, s35, s37
    s_nop 0
    buffer_load_dwordx4 v17, s[8:11], s33 offen lds
    s_add_u32 m0, m0, 1024
    s_nop 0
    buffer_load_dwordx4 v18, s[8:11], s33 offen lds
    s_add_u32 s32, s32, 128
    s_add_u32 s33, s33, s42
    s_add_u32 s31, s31, 1
    s_mov_b32 s35, 65536
    s_add_u32 m0, s35, s36
    s_nop 0
    buffer_load_dwordx4 v15, s[4:7], s32 offen lds
    s_add_u32 m0, m0, 1024
    s_nop 0
    buffer_load_dwordx4 v16, s[4:7], s32 offen lds
    s_add_u32 m0, s35, s37
    s_nop 0
    buffer_load_dwordx4 v17, s[8:11], s33 offen lds
    s_add_u32 m0, m0, 1024
    s_nop 0
    buffer_load_dwordx4 v18, s[8:11], s33 offen lds
    s_add_u32 s32, s32, 128
    s_add_u32 s33, s33, s42
    s_add_u32 s31, s31, 1
    s_mov_b32 s35, 98304
    s_mov_b32 s34, 0
    s_mov_b32 s43, 0
    s_waitcnt vmcnt(8)
    s_barrier
    s_cmp_ge_u32 s30, 4
    s_cbranch_scc1 GRPB_gemm5_kernel_34
PPL_gemm5_kernel_36:
    ds_read_b128 v[20:23], v10 offset:0
    ds_read_b128 v[36:39], v10 offset:4096
    ds_read_b64_tr_b16 v[52:53], v14 offset:0
    ds_read_b64_tr_b16 v[54:55], v14 offset:1024
    ds_read_b128 v[24:27], v11 offset:0
    ds_read_b128 v[40:43], v11 offset:4096
    ds_read_b64_tr_b16 v[56:57], v14 offset:4096
    ds_read_b64_tr_b16 v[58:59], v14 offset:5120
    ds_read_b128 v[28:31], v12 offset:0
    ds_read_b128 v[44:47], v12 offset:4096
    ds_read_b64_tr_b16 v[60:61], v14 offset:8192
    ds_read_b64_tr_b16 v[62:63], v14 offset:9216
    ds_read_b128 v[32:35], v13 offset:0
    ds_read_b128 v[48:51], v13 offset:4096
    ds_read_b64_tr_b16 v[64:65], v14 offset:12288
    ds_read_b64_tr_b16 v[66:67], v14 offset:13312
    s_cmp_ge_u32 s31, s27
    s_cbranch_scc1 PPN_gemm5_kernel_37
    s_add_u32 m0, s35, s36
    s_nop 0
    buffer_load_dwordx4 v15, s[4:7], s32 offen lds
    s_add_u32 m0, m0, 1024
    s_nop 0
    buffer_load_dwordx4 v16, s[4:7], s32 offen lds
    s_add_u32 m0, s35, s37
    s_nop 0
    buffer_load_dwordx4 v17, s[8:11], s33 offen lds
    s_add_u32 m0, m0, 1024
    s_nop 0
    buffer_load_dwordx4 v18, s[8:11], s33 offen lds
    s_add_u32 s32, s32, 128
    s_add_u32 s33, s33, s42
    s_add_u32 s31, s31, 1
PPN_gemm5_kernel_37:
    s_waitcnt lgkmcnt(0)
    s_barrier
    s_setprio 1
    v_mfma_f32_32x32x16_bf16 v[80:95], v[52:55], v[20:23], v[80:95]
    v_mfma_f32_32x32x16_bf16 v[96:111], v[52:55], v[36:39], v[96:111]
    v_mfma_f32_32x32x16_bf16 v[80:95], v[56:59], v[24:27], v[80:95]
    v_mfma_f32_32x32x16_bf16 v[96:111], v[56:59], v[40:43], v[96:111]
    v_mfma_f32_32x32x16_bf16 v[80:95], v[60:63], v[28:31], v[80:95]
    v_mfma_f32_32x32x16_bf16 v[96:111], v[60:63], v[44:47], v[96:111]
    v_mfma_f32_32x32x16_bf16 v[80:95], v[64:67], v[32:35], v[80:95]
    v_mfma_f32_32x32x16_bf16 v[96:111], v[64:67], v[48:51], v[96:111]
    s_setprio 0
    s_mov_b32 s39, s34
    s_add_u32 s34, s34, 32768
    s_cmp_eq_u32 s34, 131072
    s_cselect_b32 s34, 0, s34
    s_sub_u32 s38, s34, s39
    v_add_u32 v10, s38, v10
    v_add_u32 v11, s38, v11
    v_add_u32 v12, s38, v12
    v_add_u32 v13, s38, v13
    v_add_u32 v14, s38, v14
    s_add_u32 s35, s35, 32768
    s_cmp_eq_u32 s35, 131072
    s_cselect_b32 s35, 0, s35
    s_add_u32 s43, s43, 1
    s_add_u32 s38, s43, 3
    s_cmp_eq_u32 s38, s31
    s_cbranch_scc1 PX0_gemm5_kernel_40
    s_waitcnt vmcnt(0)
    s_branch PX1_gemm5_kernel_41
PX0_gemm5_kernel_40:
    s_waitcnt vmcnt(8)
PX1_gemm5_kernel_41:
    s_barrier
    s_cmp_lt_u32 s43, s27
    s_cbranch_scc1 PPL_gemm5_kernel_36
    s_barrier
    s_branch PPD_gemm5_kernel_35
GRPB_gemm5_kernel_34:
    s_barrier
PPL_gemm5_kernel_42:
    ds_read_b128 v[20:23], v10 offset:0
    ds_read_b128 v[36:39], v10 offset:4096
    ds_read_b64_tr_b16 v[52:53], v14 offset:0
    ds_read_b64_tr_b16 v[54:55], v14 offset:1024
    ds_read_b128 v[24:27], v11 offset:0
    ds_read_b128 v[40:43], v11 offset:4096
    ds_read_b64_tr_b16 v[56:57], v14 offset:4096
    ds_read_b64_tr_b16 v[58:59], v14 offset:5120
    ds_read_b128 v[28:31], v12 offset:0
    ds_read_b128 v[44:47], v12 offset:4096
    ds_read_b64_tr_b16 v[60:61], v14 offset:8192
    ds_read_b64_tr_b16 v[62:63], v14 offset:9216
    ds_read_b128 v[32:35], v13 offset:0
    ds_read_b128 v[48:51], v13 offset:4096
    ds_read_b64_tr_b16 v[64:65], v14 offset:12288
    ds_read_b64_tr_b16 v[66:67], v14 offset:13312
    s_cmp_ge_u32 s31, s27
    s_cbranch_scc1 PPN_gemm5_kernel_43
    s_add_u32 m0, s35, s36
    s_nop 0
    buffer_load_dwordx4 v15, s[4:7], s32 offen lds
    s_add_u32 m0, m0, 1024
    s_nop 0
    buffer_load_dwordx4 v16, s[4:7], s32 offen lds
    s_add_u32 m0, s35, s37
    s_nop 0
    buffer_load_dwordx4 v17, s[8:11], s33 offen lds
    s_add_u32 m0, m0, 1024
    s_nop 0
    buffer_load_dwordx4 v18, s[8:11], s33 offen lds
    s_add_u32 s32, s32, 128
    s_add_u32 s33, s33, s42
    s_add_u32 s31, s31, 1
PPN_gemm5_kernel_43:
    s_add_u32 s38, s43, 4
    s_cmp_eq_u32 s38, s31
    s_cbranch_scc1 PW0_gemm5_kernel_44
    s_waitcnt vmcnt(0) lgkmcnt(0)
    s_branch PW1_gemm5_kernel_45
PW0_gemm5_kernel_44:
    s_waitcnt vmcnt(8) lgkmcnt(0)
PW1_gemm5_kernel_45:
    s_barrier
    s_setprio 1
    v_mfma_f32_32x32x16_bf16 v[80:95], v[52:55], v[20:23], v[80:95]
    v_mfma_f32_32x32x16_bf16 v[96:111], v[52:55], v[36:39], v[96:111]
    v_mfma_f32_32x32x16_bf16 v[80:95], v[56:59], v[24:27], v[80:95]
    v_mfma_f32_32x32x16_bf16 v[96:111], v[56:59], v[40:43], v[96:111]
    v_mfma_f32_32x32x16_bf16 v[80:95], v[60:63], v[28:31], v[80:95]
    v_mfma_f32_32x32x16_bf16 v[96:111], v[60:63], v[44:47], v[96:111]
    v_mfma_f32_32x32x16_bf16 v[80:95], v[64:67], v[32:35], v[80:95]
    v_mfma_f32_32x32x16_bf16 v[96:111], v[64:67], v[48:51], v[96:111]
    s_setprio 0
    s_mov_b32 s39, s34
    s_add_u32 s34, s34, 32768
    s_cmp_eq_u32 s34, 131072
    s_cselect_b32 s34, 0, s34
    s_sub_u32 s38, s34, s39
    v_add_u32 v10, s38, v10
    v_add_u32 v11, s38, v11
    v_add_u32 v12, s38, v12
    v_add_u32 v13, s38, v13
    v_add_u32 v14, s38, v14
    s_add_u32 s35, s35, 32768
    s_cmp_eq_u32 s35, 131072
    s_cselect_b32 s35, 0, s35
    s_add_u32 s43, s43, 1
    s_barrier
    s_cmp_lt_u32 s43, s27
    s_cbranch_scc1 PPL_gemm5_kernel_42
PPD_gemm5_kernel_35:
    s_sub_u32 s38, 0, s34
    v_add_u32 v10, s38, v10
    v_add_u32 v11, s38, v11
    v_add_u32 v12, s38, v12
    v_add_u32 v13, s38, v13
    v_add_u32 v14, s38, v14
    s_nop 15
    s_nop 7
    s_lshl_b32 s61, s60, 16
    s_mul_i32 s62, s30, 8192
    s_add_u32 s61, s61, s62
    v_and_b32 v1, 63, v0
    v_lshlrev_b32 v1, 4, v1
    buffer_store_dwordx4 v[80:83], v1, s[52:55], s61 offen offset:0 sc1
    buffer_store_dwordx4 v[84:87], v1, s[52:55], s61 offen offset:1024 sc1
    buffer_store_dwordx4 v[88:91], v1, s[52:55], s61 offen offset:2048 sc1
    buffer_store_dwordx4 v[92:95], v1, s[52:55], s61 offen offset:3072 sc1
    s_add_u32 s61, s61, 4096
    buffer_store_dwordx4 v[96:99], v1, s[52:55], s61 offen offset:0 sc1
    buffer_store_dwordx4 v[100:103], v1, s[52:55], s61 offen offset:1024 sc1
    buffer_store_dwordx4 v[104:107], v1, s[52:55], s61 offen offset:2048 sc1
    buffer_store_dwordx4 v[108:111], v1, s[52:55], s61 offen offset:3072 sc1
    s_waitcnt vmcnt(0)
    s_barrier
    s_cmp_lg_u32 s30, 0
    s_cbranch_scc1 END_gemm5_kernel_1
    s_lshl_b32 s61, s60, 2
    v_mov_b32 v1, s61
    v_mov_b32 v2, 0x5a5a
    v_cmp_eq_u32 vcc, 0, v0
    s_and_saveexec_b64 s[62:63], vcc
    buffer_store_dword v2, v1, s[56:59], 0 offen sc1
END_gemm5_kernel_1:
    s_endpgm
.section .rodata,"a"
.p2align 6
.amdhsa_kernel prep_kernel
  .amdhsa_next_free_vgpr 48
  .amdhsa_next_free_sgpr 102
  .amdhsa_accum_offset 48
  .amdhsa_group_segment_fixed_size 0
  .amdhsa_kernarg_size 104
  .amdhsa_user_sgpr_count 2
  .amdhsa_user_sgpr_kernarg_segment_ptr 1
  .amdhsa_system_sgpr_workgroup_id_x 1
.end_amdhsa_kernel
.p2align 6
.amdhsa_kernel gemm1_kernel
  .amdhsa_next_free_vgpr 160
  .amdhsa_next_free_sgpr 102
  .amdhsa_accum_offset 160
  .amdhsa_group_segment_fixed_size 0
  .amdhsa_kernarg_size 104
  .amdhsa_user_sgpr_count 2
  .amdhsa_user_sgpr_kernarg_segment_ptr 1
  .amdhsa_system_sgpr_workgroup_id_x 1
.end_amdhsa_kernel
.p2align 6
.amdhsa_kernel g2kv_kernel
  .amdhsa_next_free_vgpr 184
  .amdhsa_next_free_sgpr 102
  .amdhsa_accum_offset 184
  .amdhsa_group_segment_fixed_size 0
  .amdhsa_kernarg_size 104
  .amdhsa_user_sgpr_count 2
  .amdhsa_user_sgpr_kernarg_segment_ptr 1
  .amdhsa_system_sgpr_workgroup_id_x 1
.end_amdhsa_kernel
.p2align 6
.amdhsa_kernel ln1_kernel
  .amdhsa_next_free_vgpr 48
  .amdhsa_next_free_sgpr 102
  .amdhsa_accum_offset 48
  .amdhsa_group_segment_fixed_size 0
  .amdhsa_kernarg_size 104
  .amdhsa_user_sgpr_count 2
  .amdhsa_user_sgpr_kernarg_segment_ptr 1
  .amdhsa_system_sgpr_workgroup_id_x 1
.end_amdhsa_kernel
.p2align 6
.amdhsa_kernel g4at_kernel
  .amdhsa_next_free_vgpr 192
  .amdhsa_next_free_sgpr 102
  .amdhsa_accum_offset 192
  .amdhsa_group_segment_fixed_size 0
  .amdhsa_kernarg_size 104
  .amdhsa_user_sgpr_count 2
  .amdhsa_user_sgpr_kernarg_segment_ptr 1
  .amdhsa_system_sgpr_workgroup_id_x 1
.end_amdhsa_kernel
.p2align 6
.amdhsa_kernel gemm5_kernel
  .amdhsa_next_free_vgpr 144
  .amdhsa_next_free_sgpr 102
  .amdhsa_accum_offset 144
  .amdhsa_group_segment_fixed_size 0
  .amdhsa_kernarg_size 104
  .amdhsa_user_sgpr_count 2
  .amdhsa_user_sgpr_kernarg_segment_ptr 1
  .amdhsa_system_sgpr_workgroup_id_x 1
.end_amdhsa_kernel
.p2align 6
```
